```python
import torch

def _softmax(x, axis=-1):
    return torch.softmax(x, dim=axis)
def _gelu(x):
    return torch.nn.functional.gelu(x, approximate="tanh")
def _silu(x):
    return torch.nn.functional.silu(x)
def _sigmoid(x):
    return torch.sigmoid(x)
def _layernorm(x, axis=-1, eps=1e-5):
    m = x.mean(dim=axis, keepdim=True)
    v = x.var(dim=axis, keepdim=True, unbiased=False)
    return (x - m) / torch.sqrt(v + eps)
def _scatter_add(tgt, idx, src, axis=0):
    return tgt.clone().index_add_(axis, idx, src)
def _segment_sum(src, seg, n):
    out = torch.zeros((n,) + src.shape[1:], dtype=src.dtype)
    return out.index_add_(0, seg, src)
def _pad(x, pw):
    flat = tuple(v for pair in reversed(pw) for v in pair)
    return torch.nn.functional.pad(x, flat)

kernel_name = 'sequential_preLN__compressed_kv_cla__dense_activation_silu__decode'

def setup_inputs():

    _w = (lambda a: (lambda t: t.to(torch.bfloat16) if t.is_floating_point() else t)(torch.as_tensor(a)))
    def _A_setup():
        B, H, Sq, Sk, D, M = 4, 32, 1, 4096, 128, 640
        Dc = 4 * D
        return {
            "x": _w((lambda *s: torch.randn(*s, dtype=torch.bfloat16) * 0.05)(B, Sq, M)),
            "c_kv": _w((lambda *s: torch.randn(*s, dtype=torch.bfloat16) * 0.8)(B, Sk, Dc)),
            "w_q": _w((lambda *s: torch.randn(*s, dtype=torch.bfloat16) * 3.2)(M, H, D) * (M ** -0.5)),
            "w_uk": _w((lambda *s: torch.randn(*s, dtype=torch.bfloat16) * 3.2)(Dc, H, D) * (Dc ** -0.5)),
            "w_uv": _w((lambda *s: torch.randn(*s, dtype=torch.bfloat16) * 0.8)(Dc, H, D) * (Dc ** -0.5)),
            "w_o": _w((lambda *s: torch.randn(*s, dtype=torch.bfloat16) * 0.8)(H, D, M) * ((H * D) ** -0.5)),
        }
    _A_in = _A_setup()

    def _B_setup():
        B, S, D, F = 4, 1, 640, 1728
        return {
            "x": _w((lambda *s: torch.randn(*s, dtype=torch.bfloat16) * 0.05)(B, S, D)),
            "w1": _w((lambda *s: torch.randn(*s, dtype=torch.bfloat16) * 3.2)(D, F) * (D ** -0.5)),
            "w2": _w((lambda *s: torch.randn(*s, dtype=torch.bfloat16) * 0.8)(F, D) * (F ** -0.5)),
        }
    _B_in = _B_setup()

    return {
        "A_x": _A_in["x"],
        "A_c_kv": _A_in["c_kv"],
        "A_w_q": _A_in["w_q"],
        "A_w_uk": _A_in["w_uk"],
        "A_w_uv": _A_in["w_uv"],
        "A_w_o": _A_in["w_o"],
        "B_x": _B_in["x"],
        "B_w1": _B_in["w1"],
        "B_w2": _B_in["w2"],
    }

def reference(A_x, A_c_kv, A_w_q, A_w_uk, A_w_uv, A_w_o, B_x, B_w1, B_w2):
    def _A_ref(x, c_kv, w_q, w_uk, w_uv, w_o):
        B, Sq, M = x.shape[0], x.shape[1], x.shape[2]
        Sk = c_kv.shape[1]
        H, D = w_q.shape[1], w_q.shape[2]
        q = torch.einsum("bqm,mhd->bhqd", x, w_q)
        k = torch.einsum("bkc,chd->bhkd", c_kv, w_uk)
        v = torch.einsum("bkc,chd->bhkd", c_kv, w_uv)
        scores = torch.einsum("bhqd,bhkd->bhqk", q, k) * (D ** -0.5)
        off = Sk - Sq
        qi = torch.arange(Sq)[:, None]
        kj = torch.arange(Sk)[None, :]
        cmask = kj <= (qi + off)
        scores = torch.where(cmask[None, None], scores, -1e9)
        p = _softmax(scores, axis=-1)
        ctx = torch.einsum("bhqk,bhkd->bhqd", p, v)
        return torch.einsum("bhqd,hdm->bqm", ctx, w_o)

    def _B_ref(x, w1, w2):
        h = torch.einsum("bsd,df->bsf", x, w1)
        h = _silu(h)
        out = torch.einsum("bsf,fd->bsd", h, w2)
        return out

    x = A_x
    h = x + _A_ref(_layernorm(x, axis=-1), A_c_kv, A_w_q, A_w_uk, A_w_uv, A_w_o)
    h2 = h + _B_ref(_layernorm(h, axis=-1), B_w1, B_w2)
    return h2
```

```asm
; @launch grid=(256,1,1) block=(512,1,1) lds=163840
.amdgcn_target "amdgcn-amd-amdhsa--gfx950"
.text
.globl sequential_preLN__compressed_kv_cla__dense_activation_silu__decode_kernel
.p2align 8
.type sequential_preLN__compressed_kv_cla__dense_activation_silu__decode_kernel,@function
sequential_preLN__compressed_kv_cla__dense_activation_silu__decode_kernel:
    s_cmp_ge_u32 s2, 256
    s_cbranch_scc1 L_end
    s_load_dwordx2 s[36:37], s[0:1], 16
    s_load_dwordx2 s[28:29], s[0:1], 0
    s_load_dwordx2 s[32:33], s[0:1], 8
    s_load_dwordx2 s[40:41], s[0:1], 24
    s_load_dwordx2 s[64:65], s[0:1], 88
    s_lshr_b32 s69, s2, 3
    v_lshrrev_b32 v1, 6, v0
    v_and_b32 v0, 63, v0
    v_readfirstlane_b32 s70, v1
    v_lshlrev_b32 v6, 4, v0
    s_cmp_lg_u32 s70, 7
    s_cbranch_scc1 L_nopf
    s_getpc_b64 s[92:93]
L_pc:
    s_lshl_b32 s90, s69, 10
    v_add_u32 v250, s90, v6
    s_mov_b32 s94, L_codeend-L_pc-16
    v_mov_b32 v251, s93
    v_cmp_gt_u32 s[96:97], s94, v250
    v_add_co_u32 v250, vcc, s92, v250
    s_nop 1
    v_addc_co_u32 v251, vcc, 0, v251, vcc
    s_and_saveexec_b64 s[94:95], s[96:97]
    s_cbranch_execz L_pfx
    global_load_dwordx4 v[252:255], v[250:251], off
L_pfx:
    s_mov_b64 exec, s[94:95]
L_nopf:
    s_mov_b32 s38, 5242880
    s_mov_b32 s39, 0x00020000
    s_mov_b32 s30, 5120
    s_mov_b32 s31, 0x00020000
    s_mov_b32 s34, 16777216
    s_mov_b32 s35, 0x00020000
    s_mov_b32 s42, 4194304
    s_mov_b32 s43, 0x00020000
    s_mov_b32 s66, 16777216
    s_mov_b32 s67, 0x00020000
    s_and_b32 s68, s2, 7
    s_mov_b32 s74, 0x05040100
    s_mov_b32 s75, 0x07060302
    s_mov_b32 s76, 0
    s_mov_b32 s71, 0
    s_and_b32 s78, s69, 3
    s_lshl_b32 s77, s68, 2
    s_add_u32 s77, s77, s78
    s_lshl_b32 s88, s77, 8
    v_lshrrev_b32 v1, 4, v0
    v_and_b32 v2, 15, v0
    v_bfe_u32 v3, v0, 2, 2
    v_and_b32 v4, 3, v0
    v_lshrrev_b32 v5, 2, v0
    v_lshlrev_b32 v7, 6, v1
    v_lshl_add_u32 v7, v4, 4, v7
    s_bfe_u32 s79, s69, 0x20002
    s_lshl_b32 s80, s79, 22
    s_lshl_b32 s81, s77, 17
    s_add_u32 s80, s80, s81
    s_xor_b32 s3, s70, 4
    s_cmp_lt_u32 s69, 16
    s_cselect_b32 s3, s3, s70
    s_and_b32 s81, s3, 4
    s_lshl_b32 s81, s81, 4
    s_and_b32 s90, s3, 3
    s_add_u32 s81, s81, s90
    s_lshl_b32 s90, s81, 10
    s_add_u32 s80, s80, s90
    s_mul_i32 s81, s81, 1056
    s_mul_i32 s87, s79, 160
    s_lshl_b32 s90, s70, 5
    s_add_u32 s87, s87, s90
    s_lshl_b32 s89, s87, 13
    s_add_u32 s89, s89, s88
    v_lshlrev_b32 v9, 16, v1
    v_lshl_add_u32 v9, v2, 4, v9
    v_lshl_add_u32 v10, v3, 15, v7
    s_lshl_b32 s91, s79, 7
    s_and_b32 s90, s70, 3
    s_lshl_b32 s90, s90, 5
    s_add_u32 s91, s91, s90
    s_lshl_b32 s91, s91, 13
    s_add_u32 s91, s91, s88
    s_cmp_lt_u32 s69, 16
    s_waitcnt lgkmcnt(0)
    s_load_dwordx2 s[82:83], s[64:65], 0
    s_cbranch_scc0 L_frontB
    s_cmp_gt_u32 s70, 3
    s_cbranch_scc1 L_notS1
    buffer_load_dwordx4 v[16:19], v9, s[36:39], s89 offen
    s_add_u32 s89, s89, 8192
    buffer_load_dwordx4 v[20:23], v9, s[36:39], s89 offen
    s_add_u32 s89, s89, 8192
    buffer_load_dwordx4 v[24:27], v9, s[36:39], s89 offen
    s_add_u32 s89, s89, 8192
    buffer_load_dwordx4 v[28:31], v9, s[36:39], s89 offen
    s_add_u32 s89, s89, 8192
    s_barrier
    buffer_load_dwordx4 v[32:35], v9, s[36:39], s89 offen
    s_add_u32 s89, s89, 8192
    buffer_load_dwordx4 v[36:39], v9, s[36:39], s89 offen
    s_add_u32 s89, s89, 8192
    buffer_load_dwordx4 v[40:43], v9, s[36:39], s89 offen
    s_add_u32 s89, s89, 8192
    buffer_load_dwordx4 v[44:47], v9, s[36:39], s89 offen
    s_add_u32 s89, s89, 991232
    s_sub_u32 s90, s89, 5242880
    s_cmp_ge_u32 s89, 5242880
    s_cselect_b32 s89, s90, s89
    buffer_load_dwordx4 v[48:51], v9, s[36:39], s89 offen
    s_add_u32 s89, s89, 8192
    buffer_load_dwordx4 v[52:55], v9, s[36:39], s89 offen
    s_add_u32 s89, s89, 8192
    buffer_load_dwordx4 v[56:59], v9, s[36:39], s89 offen
    s_add_u32 s89, s89, 8192
    buffer_load_dwordx4 v[60:63], v9, s[36:39], s89 offen
    s_add_u32 s89, s89, 8192
    buffer_load_dwordx4 v[64:67], v9, s[36:39], s89 offen
    s_add_u32 s89, s89, 8192
    buffer_load_dwordx4 v[68:71], v9, s[36:39], s89 offen
    s_add_u32 s89, s89, 8192
    buffer_load_dwordx4 v[72:75], v9, s[36:39], s89 offen
    s_add_u32 s89, s89, 8192
    buffer_load_dwordx4 v[76:79], v9, s[36:39], s89 offen
    s_add_u32 s89, s89, 991232
    s_sub_u32 s90, s89, 5242880
    s_cmp_ge_u32 s89, 5242880
    s_cselect_b32 s89, s90, s89
    buffer_load_dwordx4 v[80:83], v9, s[36:39], s89 offen
    s_add_u32 s89, s89, 8192
    buffer_load_dwordx4 v[84:87], v9, s[36:39], s89 offen
    s_add_u32 s89, s89, 8192
    buffer_load_dwordx4 v[88:91], v9, s[36:39], s89 offen
    s_add_u32 s89, s89, 8192
    buffer_load_dwordx4 v[92:95], v9, s[36:39], s89 offen
    s_add_u32 s89, s89, 8192
    buffer_load_dwordx4 v[96:99], v9, s[36:39], s89 offen
    s_add_u32 s89, s89, 8192
    buffer_load_dwordx4 v[100:103], v9, s[36:39], s89 offen
    s_add_u32 s89, s89, 8192
    buffer_load_dwordx4 v[104:107], v9, s[36:39], s89 offen
    s_add_u32 s89, s89, 8192
    buffer_load_dwordx4 v[108:111], v9, s[36:39], s89 offen
    s_add_u32 s89, s89, 991232
    s_sub_u32 s90, s89, 5242880
    s_cmp_ge_u32 s89, 5242880
    s_cselect_b32 s89, s90, s89
    v_mul_u32_u24 v8, 1296, v3
    v_lshl_add_u32 v8, v1, 4, v8
    v_add_u32 v8, 135168, v8
    s_barrier
    s_lshl_b32 s90, s87, 1
    v_add_u32 v11, s90, v8
    ds_read_b128 v[208:211], v11
    s_add_u32 s87, s87, 128
    s_sub_u32 s90, s87, 640
    s_cmp_ge_u32 s87, 640
    s_cselect_b32 s87, s90, s87
    s_lshl_b32 s90, s87, 1
    v_add_u32 v11, s90, v8
    ds_read_b128 v[212:215], v11
    s_add_u32 s87, s87, 128
    s_sub_u32 s90, s87, 640
    s_cmp_ge_u32 s87, 640
    s_cselect_b32 s87, s90, s87
    s_lshl_b32 s90, s87, 1
    v_add_u32 v11, s90, v8
    ds_read_b128 v[216:219], v11
    s_add_u32 s87, s87, 128
    s_sub_u32 s90, s87, 640
    s_cmp_ge_u32 s87, 640
    s_cselect_b32 s87, s90, s87
    s_lshl_b32 s90, s87, 1
    v_add_u32 v11, s90, v8
    ds_read_b128 v[220:223], v11
    s_add_u32 s87, s87, 128
    s_sub_u32 s90, s87, 640
    s_cmp_ge_u32 s87, 640
    s_cselect_b32 s87, s90, s87
    s_lshl_b32 s90, s87, 1
    v_add_u32 v11, s90, v8
    ds_read_b128 v[224:227], v11
    buffer_load_dwordx4 v[112:115], v9, s[36:39], s89 offen
    s_add_u32 s89, s89, 8192
    buffer_load_dwordx4 v[116:119], v9, s[36:39], s89 offen
    s_add_u32 s89, s89, 8192
    buffer_load_dwordx4 v[120:123], v9, s[36:39], s89 offen
    s_add_u32 s89, s89, 8192
    buffer_load_dwordx4 v[124:127], v9, s[36:39], s89 offen
    s_add_u32 s89, s89, 8192
    buffer_load_dwordx4 v[128:131], v9, s[36:39], s89 offen
    s_add_u32 s89, s89, 8192
    buffer_load_dwordx4 v[132:135], v9, s[36:39], s89 offen
    s_add_u32 s89, s89, 8192
    buffer_load_dwordx4 v[136:139], v9, s[36:39], s89 offen
    s_add_u32 s89, s89, 8192
    buffer_load_dwordx4 v[140:143], v9, s[36:39], s89 offen
    s_add_u32 s89, s89, 991232
    s_sub_u32 s90, s89, 5242880
    s_cmp_ge_u32 s89, 5242880
    s_cselect_b32 s89, s90, s89
    s_waitcnt lgkmcnt(0)
    s_mul_i32 s72, s82, 0x9E3779B1
    s_add_u32 s72, s72, 0x7F4A7C15
    s_mul_i32 s73, s83, 0x2C9277B5
    s_add_u32 s73, s73, 0xAC564B05
    s_waitcnt vmcnt(24)
    v_perm_b32 v176, v20, v16, s74
    v_perm_b32 v177, v28, v24, s74
    v_perm_b32 v178, v36, v32, s74
    v_perm_b32 v179, v44, v40, s74
    v_perm_b32 v180, v20, v16, s75
    v_perm_b32 v181, v28, v24, s75
    v_perm_b32 v182, v36, v32, s75
    v_perm_b32 v183, v44, v40, s75
    v_mfma_f32_16x16x32_bf16 v[144:147], v[208:211], v[176:179], 0
    v_perm_b32 v184, v21, v17, s74
    v_perm_b32 v185, v29, v25, s74
    v_perm_b32 v186, v37, v33, s74
    v_perm_b32 v187, v45, v41, s74
    v_mfma_f32_16x16x32_bf16 v[148:151], v[208:211], v[180:183], 0
    v_perm_b32 v188, v21, v17, s75
    v_perm_b32 v189, v29, v25, s75
    v_perm_b32 v190, v37, v33, s75
    v_perm_b32 v191, v45, v41, s75
    v_mfma_f32_16x16x32_bf16 v[152:155], v[208:211], v[184:187], 0
    v_perm_b32 v192, v22, v18, s74
    v_perm_b32 v193, v30, v26, s74
    v_perm_b32 v194, v38, v34, s74
    v_perm_b32 v195, v46, v42, s74
    v_mfma_f32_16x16x32_bf16 v[156:159], v[208:211], v[188:191], 0
    v_perm_b32 v196, v22, v18, s75
    v_perm_b32 v197, v30, v26, s75
    v_perm_b32 v198, v38, v34, s75
    v_perm_b32 v199, v46, v42, s75
    v_mfma_f32_16x16x32_bf16 v[160:163], v[208:211], v[192:195], 0
    v_perm_b32 v200, v23, v19, s74
    v_perm_b32 v201, v31, v27, s74
    v_perm_b32 v202, v39, v35, s74
    v_perm_b32 v203, v47, v43, s74
    v_mfma_f32_16x16x32_bf16 v[164:167], v[208:211], v[196:199], 0
    v_perm_b32 v204, v23, v19, s75
    v_perm_b32 v205, v31, v27, s75
    v_perm_b32 v206, v39, v35, s75
    v_perm_b32 v207, v47, v43, s75
    v_mfma_f32_16x16x32_bf16 v[168:171], v[208:211], v[200:203], 0
    s_nop 0
    v_mfma_f32_16x16x32_bf16 v[172:175], v[208:211], v[204:207], 0
    buffer_load_dwordx4 v[16:19], v9, s[36:39], s89 offen
    s_add_u32 s89, s89, 8192
    buffer_load_dwordx4 v[20:23], v9, s[36:39], s89 offen
    s_add_u32 s89, s89, 8192
    buffer_load_dwordx4 v[24:27], v9, s[36:39], s89 offen
    s_add_u32 s89, s89, 8192
    buffer_load_dwordx4 v[28:31], v9, s[36:39], s89 offen
    s_add_u32 s89, s89, 8192
    buffer_load_dwordx4 v[32:35], v9, s[36:39], s89 offen
    s_add_u32 s89, s89, 8192
    buffer_load_dwordx4 v[36:39], v9, s[36:39], s89 offen
    s_add_u32 s89, s89, 8192
    buffer_load_dwordx4 v[40:43], v9, s[36:39], s89 offen
    s_add_u32 s89, s89, 8192
    buffer_load_dwordx4 v[44:47], v9, s[36:39], s89 offen
    s_waitcnt vmcnt(24)
    v_perm_b32 v176, v52, v48, s74
    v_perm_b32 v177, v60, v56, s74
    v_perm_b32 v178, v68, v64, s74
    v_perm_b32 v179, v76, v72, s74
    v_perm_b32 v180, v52, v48, s75
    v_perm_b32 v181, v60, v56, s75
    v_perm_b32 v182, v68, v64, s75
    v_perm_b32 v183, v76, v72, s75
    v_mfma_f32_16x16x32_bf16 v[144:147], v[212:215], v[176:179], v[144:147]
    v_perm_b32 v184, v53, v49, s74
    v_perm_b32 v185, v61, v57, s74
    v_perm_b32 v186, v69, v65, s74
    v_perm_b32 v187, v77, v73, s74
    v_mfma_f32_16x16x32_bf16 v[148:151], v[212:215], v[180:183], v[148:151]
    v_perm_b32 v188, v53, v49, s75
    v_perm_b32 v189, v61, v57, s75
    v_perm_b32 v190, v69, v65, s75
    v_perm_b32 v191, v77, v73, s75
    v_mfma_f32_16x16x32_bf16 v[152:155], v[212:215], v[184:187], v[152:155]
    v_perm_b32 v192, v54, v50, s74
    v_perm_b32 v193, v62, v58, s74
    v_perm_b32 v194, v70, v66, s74
    v_perm_b32 v195, v78, v74, s74
    v_mfma_f32_16x16x32_bf16 v[156:159], v[212:215], v[188:191], v[156:159]
    v_perm_b32 v196, v54, v50, s75
    v_perm_b32 v197, v62, v58, s75
    v_perm_b32 v198, v70, v66, s75
    v_perm_b32 v199, v78, v74, s75
    v_mfma_f32_16x16x32_bf16 v[160:163], v[212:215], v[192:195], v[160:163]
    v_perm_b32 v200, v55, v51, s74
    v_perm_b32 v201, v63, v59, s74
    v_perm_b32 v202, v71, v67, s74
    v_perm_b32 v203, v79, v75, s74
    v_mfma_f32_16x16x32_bf16 v[164:167], v[212:215], v[196:199], v[164:167]
    v_perm_b32 v204, v55, v51, s75
    v_perm_b32 v205, v63, v59, s75
    v_perm_b32 v206, v71, v67, s75
    v_perm_b32 v207, v79, v75, s75
    v_mfma_f32_16x16x32_bf16 v[168:171], v[212:215], v[200:203], v[168:171]
    s_nop 0
    v_mfma_f32_16x16x32_bf16 v[172:175], v[212:215], v[204:207], v[172:175]
    s_add_u32 s90, s91, 0
    buffer_load_dwordx4 v[48:51], v10, s[40:43], s90 offen
    s_add_u32 s90, s91, 8192
    buffer_load_dwordx4 v[52:55], v10, s[40:43], s90 offen
    s_add_u32 s90, s91, 16384
    buffer_load_dwordx4 v[56:59], v10, s[40:43], s90 offen
    s_add_u32 s90, s91, 24576
    buffer_load_dwordx4 v[60:63], v10, s[40:43], s90 offen
    s_add_u32 s90, s91, 131072
    buffer_load_dwordx4 v[64:67], v10, s[40:43], s90 offen
    s_add_u32 s90, s91, 139264
    buffer_load_dwordx4 v[68:71], v10, s[40:43], s90 offen
    s_add_u32 s90, s91, 147456
    buffer_load_dwordx4 v[72:75], v10, s[40:43], s90 offen
    s_add_u32 s90, s91, 155648
    buffer_load_dwordx4 v[76:79], v10, s[40:43], s90 offen
    s_barrier
    v_mul_u32_u24 v12, 576, v1
    v_lshl_add_u32 v12, v2, 5, v12
    v_lshl_add_u32 v12, v3, 4, v12
    s_mul_i32 s90, s70, 2304
    s_add_u32 s90, s90, 140544
    v_add_u32 v12, s90, v12
    s_waitcnt vmcnt(24)
    v_perm_b32 v176, v84, v80, s74
    v_perm_b32 v177, v92, v88, s74
    v_perm_b32 v178, v100, v96, s74
    v_perm_b32 v179, v108, v104, s74
    v_perm_b32 v180, v84, v80, s75
    v_perm_b32 v181, v92, v88, s75
    v_perm_b32 v182, v100, v96, s75
    v_perm_b32 v183, v108, v104, s75
    v_mfma_f32_16x16x32_bf16 v[144:147], v[216:219], v[176:179], v[144:147]
    v_perm_b32 v184, v85, v81, s74
    v_perm_b32 v185, v93, v89, s74
    v_perm_b32 v186, v101, v97, s74
    v_perm_b32 v187, v109, v105, s74
    v_mfma_f32_16x16x32_bf16 v[148:151], v[216:219], v[180:183], v[148:151]
    v_perm_b32 v188, v85, v81, s75
    v_perm_b32 v189, v93, v89, s75
    v_perm_b32 v190, v101, v97, s75
    v_perm_b32 v191, v109, v105, s75
    v_mfma_f32_16x16x32_bf16 v[152:155], v[216:219], v[184:187], v[152:155]
    v_perm_b32 v192, v86, v82, s74
    v_perm_b32 v193, v94, v90, s74
    v_perm_b32 v194, v102, v98, s74
    v_perm_b32 v195, v110, v106, s74
    v_mfma_f32_16x16x32_bf16 v[156:159], v[216:219], v[188:191], v[156:159]
    v_perm_b32 v196, v86, v82, s75
    v_perm_b32 v197, v94, v90, s75
    v_perm_b32 v198, v102, v98, s75
    v_perm_b32 v199, v110, v106, s75
    v_mfma_f32_16x16x32_bf16 v[160:163], v[216:219], v[192:195], v[160:163]
    v_perm_b32 v200, v87, v83, s74
    v_perm_b32 v201, v95, v91, s74
    v_perm_b32 v202, v103, v99, s74
    v_perm_b32 v203, v111, v107, s74
    v_mfma_f32_16x16x32_bf16 v[164:167], v[216:219], v[196:199], v[164:167]
    v_perm_b32 v204, v87, v83, s75
    v_perm_b32 v205, v95, v91, s75
    v_perm_b32 v206, v103, v99, s75
    v_perm_b32 v207, v111, v107, s75
    v_mfma_f32_16x16x32_bf16 v[168:171], v[216:219], v[200:203], v[168:171]
    s_nop 0
    v_mfma_f32_16x16x32_bf16 v[172:175], v[216:219], v[204:207], v[172:175]
    v_mul_u32_u24 v11, 576, v4
    v_lshl_add_u32 v11, v5, 5, v11
    v_lshl_add_u32 v11, v1, 4, v11
    v_add_u32 v11, 140544, v11
    v_bfe_u32 v8, v0, 2, 1
    v_bfe_u32 v13, v0, 3, 2
    v_lshlrev_b32 v14, 4, v4
    v_lshl_add_u32 v14, v8, 2, v14
    v_add_u32 v14, v14, v13
    v_lshlrev_b32 v14, 2, v14
    v_and_b32 v15, 7, v0
    v_lshlrev_b32 v15, 4, v15
    v_lshl_add_u32 v15, v13, 16, v15
    s_lshl_b32 s89, s77, 11
    s_lshl_b32 s90, s79, 9
    s_add_u32 s89, s89, s90
    s_lshl_b32 s90, s70, 7
    s_add_u32 s89, s89, s90
    s_add_u32 s89, s89, 1048576
    s_waitcnt vmcnt(16)
    v_perm_b32 v176, v116, v112, s74
    v_perm_b32 v177, v124, v120, s74
    v_perm_b32 v178, v132, v128, s74
    v_perm_b32 v179, v140, v136, s74
    v_perm_b32 v180, v116, v112, s75
    v_perm_b32 v181, v124, v120, s75
    v_perm_b32 v182, v132, v128, s75
    v_perm_b32 v183, v140, v136, s75
    v_mfma_f32_16x16x32_bf16 v[144:147], v[220:223], v[176:179], v[144:147]
    v_perm_b32 v184, v117, v113, s74
    v_perm_b32 v185, v125, v121, s74
    v_perm_b32 v186, v133, v129, s74
    v_perm_b32 v187, v141, v137, s74
    v_mfma_f32_16x16x32_bf16 v[148:151], v[220:223], v[180:183], v[148:151]
    v_perm_b32 v188, v117, v113, s75
    v_perm_b32 v189, v125, v121, s75
    v_perm_b32 v190, v133, v129, s75
    v_perm_b32 v191, v141, v137, s75
    v_mfma_f32_16x16x32_bf16 v[152:155], v[220:223], v[184:187], v[152:155]
    v_perm_b32 v192, v118, v114, s74
    v_perm_b32 v193, v126, v122, s74
    v_perm_b32 v194, v134, v130, s74
    v_perm_b32 v195, v142, v138, s74
    v_mfma_f32_16x16x32_bf16 v[156:159], v[220:223], v[188:191], v[156:159]
    v_perm_b32 v196, v118, v114, s75
    v_perm_b32 v197, v126, v122, s75
    v_perm_b32 v198, v134, v130, s75
    v_perm_b32 v199, v142, v138, s75
    v_mfma_f32_16x16x32_bf16 v[160:163], v[220:223], v[192:195], v[160:163]
    v_perm_b32 v200, v119, v115, s74
    v_perm_b32 v201, v127, v123, s74
    v_perm_b32 v202, v135, v131, s74
    v_perm_b32 v203, v143, v139, s74
    v_mfma_f32_16x16x32_bf16 v[164:167], v[220:223], v[196:199], v[164:167]
    v_perm_b32 v204, v119, v115, s75
    v_perm_b32 v205, v127, v123, s75
    v_perm_b32 v206, v135, v131, s75
    v_perm_b32 v207, v143, v139, s75
    v_mfma_f32_16x16x32_bf16 v[168:171], v[220:223], v[200:203], v[168:171]
    s_nop 0
    v_mfma_f32_16x16x32_bf16 v[172:175], v[220:223], v[204:207], v[172:175]
    s_waitcnt vmcnt(8)
    v_perm_b32 v176, v20, v16, s74
    v_perm_b32 v177, v28, v24, s74
    v_perm_b32 v178, v36, v32, s74
    v_perm_b32 v179, v44, v40, s74
    v_perm_b32 v180, v20, v16, s75
    v_perm_b32 v181, v28, v24, s75
    v_perm_b32 v182, v36, v32, s75
    v_perm_b32 v183, v44, v40, s75
    v_mfma_f32_16x16x32_bf16 v[144:147], v[224:227], v[176:179], v[144:147]
    v_perm_b32 v184, v21, v17, s74
    v_perm_b32 v185, v29, v25, s74
    v_perm_b32 v186, v37, v33, s74
    v_perm_b32 v187, v45, v41, s74
    v_mfma_f32_16x16x32_bf16 v[148:151], v[224:227], v[180:183], v[148:151]
    v_perm_b32 v188, v21, v17, s75
    v_perm_b32 v189, v29, v25, s75
    v_perm_b32 v190, v37, v33, s75
    v_perm_b32 v191, v45, v41, s75
    v_mfma_f32_16x16x32_bf16 v[152:155], v[224:227], v[184:187], v[152:155]
    v_perm_b32 v192, v22, v18, s74
    v_perm_b32 v193, v30, v26, s74
    v_perm_b32 v194, v38, v34, s74
    v_perm_b32 v195, v46, v42, s74
    v_mfma_f32_16x16x32_bf16 v[156:159], v[224:227], v[188:191], v[156:159]
    v_perm_b32 v196, v22, v18, s75
    v_perm_b32 v197, v30, v26, s75
    v_perm_b32 v198, v38, v34, s75
    v_perm_b32 v199, v46, v42, s75
    v_mfma_f32_16x16x32_bf16 v[160:163], v[224:227], v[192:195], v[160:163]
    v_perm_b32 v200, v23, v19, s74
    v_perm_b32 v201, v31, v27, s74
    v_perm_b32 v202, v39, v35, s74
    v_perm_b32 v203, v47, v43, s74
    v_mfma_f32_16x16x32_bf16 v[164:167], v[224:227], v[196:199], v[164:167]
    v_perm_b32 v204, v23, v19, s75
    v_perm_b32 v205, v31, v27, s75
    v_perm_b32 v206, v39, v35, s75
    v_perm_b32 v207, v47, v43, s75
    v_mfma_f32_16x16x32_bf16 v[168:171], v[224:227], v[200:203], v[168:171]
    s_nop 0
    v_mfma_f32_16x16x32_bf16 v[172:175], v[224:227], v[204:207], v[172:175]
    s_nop 4
    ds_write2_b32 v12, v144, v148 offset0:0 offset1:1
    ds_write2_b32 v12, v152, v156 offset0:2 offset1:3
    ds_write2_b32 v12, v160, v164 offset0:4 offset1:5
    ds_write2_b32 v12, v168, v172 offset0:6 offset1:7
    s_waitcnt lgkmcnt(0)
    s_barrier
    ds_read_b128 v[80:83], v11 offset:0
    ds_read_b128 v[84:87], v11 offset:16
    ds_read_b128 v[88:91], v11 offset:2304
    ds_read_b128 v[92:95], v11 offset:2320
    ds_read_b128 v[96:99], v11 offset:4608
    ds_read_b128 v[100:103], v11 offset:4624
    ds_read_b128 v[104:107], v11 offset:6912
    ds_read_b128 v[108:111], v11 offset:6928
    v_mov_b32 v22, s72
    v_mov_b32 v23, s73
    s_waitcnt lgkmcnt(4)
    v_pk_add_f32 v[80:81], v[80:81], v[88:89]
    v_pk_add_f32 v[82:83], v[82:83], v[90:91]
    v_pk_add_f32 v[84:85], v[84:85], v[92:93]
    v_pk_add_f32 v[86:87], v[86:87], v[94:95]
    s_waitcnt lgkmcnt(0)
    v_pk_add_f32 v[96:97], v[96:97], v[104:105]
    v_pk_add_f32 v[98:99], v[98:99], v[106:107]
    v_pk_add_f32 v[100:101], v[100:101], v[108:109]
    v_pk_add_f32 v[102:103], v[102:103], v[110:111]
    v_pk_add_f32 v[80:81], v[80:81], v[96:97]
    v_pk_add_f32 v[82:83], v[82:83], v[98:99]
    v_pk_add_f32 v[84:85], v[84:85], v[100:101]
    v_pk_add_f32 v[86:87], v[86:87], v[102:103]
    v_cvt_pk_bf16_f32 v16, v80, v81
    v_cvt_pk_bf16_f32 v17, v82, v83
    v_cvt_pk_bf16_f32 v18, v84, v85
    v_cvt_pk_bf16_f32 v19, v86, v87
    s_waitcnt vmcnt(0)
    s_nop 0
    v_mfma_f32_16x16x32_bf16 v[144:147], v[48:51], v[16:19], 0
    v_mfma_f32_16x16x32_bf16 v[148:151], v[52:55], v[16:19], 0
    v_mfma_f32_16x16x32_bf16 v[152:155], v[56:59], v[16:19], 0
    v_mfma_f32_16x16x32_bf16 v[156:159], v[60:63], v[16:19], 0
    v_mfma_f32_16x16x32_bf16 v[160:163], v[64:67], v[16:19], 0
    v_mfma_f32_16x16x32_bf16 v[164:167], v[68:71], v[16:19], 0
    v_mfma_f32_16x16x32_bf16 v[168:171], v[72:75], v[16:19], 0
    v_mfma_f32_16x16x32_bf16 v[172:175], v[76:79], v[16:19], 0
    s_nop 0
    v_add_f32_dpp v24, v145, v144 row_shl:4 row_mask:0xf bank_mask:0x1
    v_add_f32_dpp v25, v149, v148 row_shl:4 row_mask:0xf bank_mask:0x1
    v_add_f32_dpp v26, v153, v152 row_shl:4 row_mask:0xf bank_mask:0x1
    v_add_f32_dpp v27, v157, v156 row_shl:4 row_mask:0xf bank_mask:0x1
    v_add_f32_dpp v24, v146, v24 row_shl:8 row_mask:0xf bank_mask:0x1
    v_add_f32_dpp v25, v150, v25 row_shl:8 row_mask:0xf bank_mask:0x1
    v_add_f32_dpp v26, v154, v26 row_shl:8 row_mask:0xf bank_mask:0x1
    v_add_f32_dpp v27, v158, v27 row_shl:8 row_mask:0xf bank_mask:0x1
    v_add_f32_dpp v24, v147, v24 row_shl:12 row_mask:0xf bank_mask:0x1
    v_add_f32_dpp v25, v151, v25 row_shl:12 row_mask:0xf bank_mask:0x1
    v_add_f32_dpp v26, v155, v26 row_shl:12 row_mask:0xf bank_mask:0x1
    v_add_f32_dpp v27, v159, v27 row_shl:12 row_mask:0xf bank_mask:0x1
    v_add_f32_dpp v24, v160, v161 row_shr:4 row_mask:0xf bank_mask:0x2
    v_add_f32_dpp v25, v164, v165 row_shr:4 row_mask:0xf bank_mask:0x2
    v_add_f32_dpp v26, v168, v169 row_shr:4 row_mask:0xf bank_mask:0x2
    v_add_f32_dpp v27, v172, v173 row_shr:4 row_mask:0xf bank_mask:0x2
    v_add_f32_dpp v24, v162, v24 row_shl:4 row_mask:0xf bank_mask:0x2
    v_add_f32_dpp v25, v166, v25 row_shl:4 row_mask:0xf bank_mask:0x2
    v_add_f32_dpp v26, v170, v26 row_shl:4 row_mask:0xf bank_mask:0x2
    v_add_f32_dpp v27, v174, v27 row_shl:4 row_mask:0xf bank_mask:0x2
    v_add_f32_dpp v24, v163, v24 row_shl:8 row_mask:0xf bank_mask:0x2
    v_add_f32_dpp v25, v167, v25 row_shl:8 row_mask:0xf bank_mask:0x2
    v_add_f32_dpp v26, v171, v26 row_shl:8 row_mask:0xf bank_mask:0x2
    v_add_f32_dpp v27, v175, v27 row_shl:8 row_mask:0xf bank_mask:0x2
    v_cvt_pk_bf16_f32 v28, v24, v25
    v_cvt_pk_bf16_f32 v29, v26, v27
    ds_bpermute_b32 v20, v14, v28
    ds_bpermute_b32 v21, v14, v29
    s_mov_b32 exec_lo, 0xffffffff
    s_mov_b32 exec_hi, 0x0
    s_waitcnt lgkmcnt(0)
    buffer_store_dwordx4 v[20:23], v15, s[64:67], s89 offen sc1
    s_mov_b64 exec, -1
    s_barrier
    s_add_u32 m0, s81, 63360
    s_add_u32 s86, s80, 61440
    buffer_load_dwordx4 v6, s[32:35], s86 offen  lds
    s_add_u32 m0, s81, 59136
    s_add_u32 s86, s80, 57344
    buffer_load_dwordx4 v6, s[32:35], s86 offen  lds
    s_add_u32 m0, s81, 54912
    s_add_u32 s86, s80, 53248
    buffer_load_dwordx4 v6, s[32:35], s86 offen  lds
    s_add_u32 m0, s81, 50688
    s_add_u32 s86, s80, 49152
    buffer_load_dwordx4 v6, s[32:35], s86 offen  lds
    s_add_u32 m0, s81, 46464
    s_add_u32 s86, s80, 45056
    buffer_load_dwordx4 v6, s[32:35], s86 offen  lds
    s_add_u32 m0, s81, 42240
    s_add_u32 s86, s80, 40960
    buffer_load_dwordx4 v6, s[32:35], s86 offen  lds
    s_add_u32 m0, s81, 38016
    s_add_u32 s86, s80, 36864
    buffer_load_dwordx4 v6, s[32:35], s86 offen  lds
    s_add_u32 m0, s81, 33792
    s_add_u32 s86, s80, 32768
    buffer_load_dwordx4 v6, s[32:35], s86 offen  lds
    s_add_u32 m0, s81, 29568
    s_add_u32 s86, s80, 28672
    buffer_load_dwordx4 v6, s[32:35], s86 offen  lds
    s_add_u32 m0, s81, 25344
    s_add_u32 s86, s80, 24576
    buffer_load_dwordx4 v6, s[32:35], s86 offen  lds
    s_add_u32 m0, s81, 21120
    s_add_u32 s86, s80, 20480
    buffer_load_dwordx4 v6, s[32:35], s86 offen  lds
    s_add_u32 m0, s81, 16896
    s_add_u32 s86, s80, 16384
    buffer_load_dwordx4 v6, s[32:35], s86 offen  lds
    s_add_u32 m0, s81, 12672
    s_add_u32 s86, s80, 12288
    buffer_load_dwordx4 v6, s[32:35], s86 offen  lds
    s_add_u32 m0, s81, 8448
    s_add_u32 s86, s80, 8192
    buffer_load_dwordx4 v6, s[32:35], s86 offen  lds
    s_add_u32 m0, s81, 4224
    s_add_u32 s86, s80, 4096
    buffer_load_dwordx4 v6, s[32:35], s86 offen  lds
    s_add_u32 m0, s81, 0
    s_add_u32 s86, s80, 0
    buffer_load_dwordx4 v6, s[32:35], s86 offen  lds
    s_branch L_qgather
L_notS1:
    s_cmp_eq_u32 s70, 5
    s_cbranch_scc0 L_w67
    v_mul_u32_u24 v8, 1280, v1
    v_lshl_add_u32 v8, v2, 4, v8
    buffer_load_dwordx4 v[16:19], v8, s[28:31], 0 offen offset:0
    buffer_load_dwordx4 v[20:23], v8, s[28:31], 0 offen offset:256
    buffer_load_dwordx4 v[24:27], v8, s[28:31], 0 offen offset:512
    buffer_load_dwordx4 v[28:31], v8, s[28:31], 0 offen offset:768
    buffer_load_dwordx4 v[32:35], v8, s[28:31], 0 offen offset:1024
    s_barrier
    v_mov_b32 v38, 0x3f803f80
    v_mov_b32 v36, 0
    v_mov_b32 v37, 0
    v_mul_u32_u24 v8, 1296, v1
    v_lshl_add_u32 v8, v2, 4, v8
    v_add_u32 v8, 135168, v8
    s_waitcnt vmcnt(0)
    v_dot2_f32_bf16 v36, v16, v38, v36
    v_dot2_f32_bf16 v37, v16, v16, v37
    v_dot2_f32_bf16 v36, v17, v38, v36
    v_dot2_f32_bf16 v37, v17, v17, v37
    v_dot2_f32_bf16 v36, v18, v38, v36
    v_dot2_f32_bf16 v37, v18, v18, v37
    v_dot2_f32_bf16 v36, v19, v38, v36
    v_dot2_f32_bf16 v37, v19, v19, v37
    v_dot2_f32_bf16 v36, v20, v38, v36
    v_dot2_f32_bf16 v37, v20, v20, v37
    v_dot2_f32_bf16 v36, v21, v38, v36
    v_dot2_f32_bf16 v37, v21, v21, v37
    v_dot2_f32_bf16 v36, v22, v38, v36
    v_dot2_f32_bf16 v37, v22, v22, v37
    v_dot2_f32_bf16 v36, v23, v38, v36
    v_dot2_f32_bf16 v37, v23, v23, v37
    v_dot2_f32_bf16 v36, v24, v38, v36
    v_dot2_f32_bf16 v37, v24, v24, v37
    v_dot2_f32_bf16 v36, v25, v38, v36
    v_dot2_f32_bf16 v37, v25, v25, v37
    v_dot2_f32_bf16 v36, v26, v38, v36
    v_dot2_f32_bf16 v37, v26, v26, v37
    v_dot2_f32_bf16 v36, v27, v38, v36
    v_dot2_f32_bf16 v37, v27, v27, v37
    v_dot2_f32_bf16 v36, v28, v38, v36
    v_dot2_f32_bf16 v37, v28, v28, v37
    v_dot2_f32_bf16 v36, v29, v38, v36
    v_dot2_f32_bf16 v37, v29, v29, v37
    v_dot2_f32_bf16 v36, v30, v38, v36
    v_dot2_f32_bf16 v37, v30, v30, v37
    v_dot2_f32_bf16 v36, v31, v38, v36
    v_dot2_f32_bf16 v37, v31, v31, v37
    v_dot2_f32_bf16 v36, v32, v38, v36
    v_dot2_f32_bf16 v37, v32, v32, v37
    v_dot2_f32_bf16 v36, v33, v38, v36
    v_dot2_f32_bf16 v37, v33, v33, v37
    v_dot2_f32_bf16 v36, v34, v38, v36
    v_dot2_f32_bf16 v37, v34, v34, v37
    v_dot2_f32_bf16 v36, v35, v38, v36
    v_dot2_f32_bf16 v37, v35, v35, v37
    s_nop 1
    s_nop 0
    v_add_f32_dpp v36, v36, v36 row_ror:8 row_mask:0xf bank_mask:0xf
    v_add_f32_dpp v37, v37, v37 row_ror:8 row_mask:0xf bank_mask:0xf
    s_nop 0
    v_add_f32_dpp v36, v36, v36 row_ror:4 row_mask:0xf bank_mask:0xf
    v_add_f32_dpp v37, v37, v37 row_ror:4 row_mask:0xf bank_mask:0xf
    s_nop 0
    v_add_f32_dpp v36, v36, v36 row_ror:2 row_mask:0xf bank_mask:0xf
    v_add_f32_dpp v37, v37, v37 row_ror:2 row_mask:0xf bank_mask:0xf
    s_nop 0
    v_add_f32_dpp v36, v36, v36 row_ror:1 row_mask:0xf bank_mask:0xf
    v_add_f32_dpp v37, v37, v37 row_ror:1 row_mask:0xf bank_mask:0xf
    v_mul_f32 v36, 0x3acccccd, v36
    v_mul_f32 v37, 0x3acccccd, v37
    v_fma_f32 v37, -v36, v36, v37
    v_max_f32 v37, 0, v37
    v_add_f32 v37, 0x3727c5ac, v37
    v_rsq_f32 v38, v37
    s_nop 0
    v_mul_f32 v36, -v36, v38
    v_lshlrev_b32 v40, 16, v16
    v_and_b32 v41, 0xffff0000, v16
    v_pk_fma_f32 v[40:41], v[40:41], v[38:39], v[36:37] op_sel_hi:[1,0,0]
    v_cvt_pk_bf16_f32 v16, v40, v41
    v_lshlrev_b32 v40, 16, v17
    v_and_b32 v41, 0xffff0000, v17
    v_pk_fma_f32 v[40:41], v[40:41], v[38:39], v[36:37] op_sel_hi:[1,0,0]
    v_cvt_pk_bf16_f32 v17, v40, v41
    v_lshlrev_b32 v40, 16, v18
    v_and_b32 v41, 0xffff0000, v18
    v_pk_fma_f32 v[40:41], v[40:41], v[38:39], v[36:37] op_sel_hi:[1,0,0]
    v_cvt_pk_bf16_f32 v18, v40, v41
    v_lshlrev_b32 v40, 16, v19
    v_and_b32 v41, 0xffff0000, v19
    v_pk_fma_f32 v[40:41], v[40:41], v[38:39], v[36:37] op_sel_hi:[1,0,0]
    v_cvt_pk_bf16_f32 v19, v40, v41
    v_lshlrev_b32 v40, 16, v20
    v_and_b32 v41, 0xffff0000, v20
    v_pk_fma_f32 v[40:41], v[40:41], v[38:39], v[36:37] op_sel_hi:[1,0,0]
    v_cvt_pk_bf16_f32 v20, v40, v41
    v_lshlrev_b32 v40, 16, v21
    v_and_b32 v41, 0xffff0000, v21
    v_pk_fma_f32 v[40:41], v[40:41], v[38:39], v[36:37] op_sel_hi:[1,0,0]
    v_cvt_pk_bf16_f32 v21, v40, v41
    v_lshlrev_b32 v40, 16, v22
    v_and_b32 v41, 0xffff0000, v22
    v_pk_fma_f32 v[40:41], v[40:41], v[38:39], v[36:37] op_sel_hi:[1,0,0]
    v_cvt_pk_bf16_f32 v22, v40, v41
    v_lshlrev_b32 v40, 16, v23
    v_and_b32 v41, 0xffff0000, v23
    v_pk_fma_f32 v[40:41], v[40:41], v[38:39], v[36:37] op_sel_hi:[1,0,0]
    v_cvt_pk_bf16_f32 v23, v40, v41
    v_lshlrev_b32 v40, 16, v24
    v_and_b32 v41, 0xffff0000, v24
    v_pk_fma_f32 v[40:41], v[40:41], v[38:39], v[36:37] op_sel_hi:[1,0,0]
    v_cvt_pk_bf16_f32 v24, v40, v41
    v_lshlrev_b32 v40, 16, v25
    v_and_b32 v41, 0xffff0000, v25
    v_pk_fma_f32 v[40:41], v[40:41], v[38:39], v[36:37] op_sel_hi:[1,0,0]
    v_cvt_pk_bf16_f32 v25, v40, v41
    v_lshlrev_b32 v40, 16, v26
    v_and_b32 v41, 0xffff0000, v26
    v_pk_fma_f32 v[40:41], v[40:41], v[38:39], v[36:37] op_sel_hi:[1,0,0]
    v_cvt_pk_bf16_f32 v26, v40, v41
    v_lshlrev_b32 v40, 16, v27
    v_and_b32 v41, 0xffff0000, v27
    v_pk_fma_f32 v[40:41], v[40:41], v[38:39], v[36:37] op_sel_hi:[1,0,0]
    v_cvt_pk_bf16_f32 v27, v40, v41
    v_lshlrev_b32 v40, 16, v28
    v_and_b32 v41, 0xffff0000, v28
    v_pk_fma_f32 v[40:41], v[40:41], v[38:39], v[36:37] op_sel_hi:[1,0,0]
    v_cvt_pk_bf16_f32 v28, v40, v41
    v_lshlrev_b32 v40, 16, v29
    v_and_b32 v41, 0xffff0000, v29
    v_pk_fma_f32 v[40:41], v[40:41], v[38:39], v[36:37] op_sel_hi:[1,0,0]
    v_cvt_pk_bf16_f32 v29, v40, v41
    v_lshlrev_b32 v40, 16, v30
    v_and_b32 v41, 0xffff0000, v30
    v_pk_fma_f32 v[40:41], v[40:41], v[38:39], v[36:37] op_sel_hi:[1,0,0]
    v_cvt_pk_bf16_f32 v30, v40, v41
    v_lshlrev_b32 v40, 16, v31
    v_and_b32 v41, 0xffff0000, v31
    v_pk_fma_f32 v[40:41], v[40:41], v[38:39], v[36:37] op_sel_hi:[1,0,0]
    v_cvt_pk_bf16_f32 v31, v40, v41
    v_lshlrev_b32 v40, 16, v32
    v_and_b32 v41, 0xffff0000, v32
    v_pk_fma_f32 v[40:41], v[40:41], v[38:39], v[36:37] op_sel_hi:[1,0,0]
    v_cvt_pk_bf16_f32 v32, v40, v41
    v_lshlrev_b32 v40, 16, v33
    v_and_b32 v41, 0xffff0000, v33
    v_pk_fma_f32 v[40:41], v[40:41], v[38:39], v[36:37] op_sel_hi:[1,0,0]
    v_cvt_pk_bf16_f32 v33, v40, v41
    v_lshlrev_b32 v40, 16, v34
    v_and_b32 v41, 0xffff0000, v34
    v_pk_fma_f32 v[40:41], v[40:41], v[38:39], v[36:37] op_sel_hi:[1,0,0]
    v_cvt_pk_bf16_f32 v34, v40, v41
    v_lshlrev_b32 v40, 16, v35
    v_and_b32 v41, 0xffff0000, v35
    v_pk_fma_f32 v[40:41], v[40:41], v[38:39], v[36:37] op_sel_hi:[1,0,0]
    v_cvt_pk_bf16_f32 v35, v40, v41
    ds_write_b128 v8, v[16:19] offset:0
    ds_write_b128 v8, v[20:23] offset:256
    ds_write_b128 v8, v[24:27] offset:512
    ds_write_b128 v8, v[28:31] offset:768
    ds_write_b128 v8, v[32:35] offset:1024
    s_branch L_w567
L_w67:
    s_barrier
L_w567:
    s_waitcnt lgkmcnt(0)
    s_mul_i32 s72, s82, 0x9E3779B1
    s_add_u32 s72, s72, 0x7F4A7C15
    s_mul_i32 s73, s83, 0x2C9277B5
    s_add_u32 s73, s73, 0xAC564B05
    s_barrier
    s_cmp_eq_u32 s70, 7
    s_cbranch_scc0 L_w56b
    s_getreg_b32 s84, hwreg(HW_REG_XCC_ID)
    s_and_b32 s84, s84, 15
    s_lshl_b32 s85, s68, 9
    s_add_u32 s85, s85, 4096
    s_lshl_b32 s86, s69, 4
    v_mov_b32 v20, s84
    v_mov_b32 v21, 0
    v_mov_b32 v22, s72
    v_mov_b32 v23, s73
    v_mov_b32 v12, s86
    s_mov_b64 exec, 1
    buffer_store_dwordx4 v[20:23], v12, s[64:67], s85 offen sc1
    s_mov_b64 exec, -1
L_w56b:
    s_barrier
    s_add_u32 m0, s81, 0
    s_add_u32 s86, s80, 0
    buffer_load_dwordx4 v6, s[32:35], s86 offen  lds
    s_add_u32 m0, s81, 4224
    s_add_u32 s86, s80, 4096
    buffer_load_dwordx4 v6, s[32:35], s86 offen  lds
    s_add_u32 m0, s81, 8448
    s_add_u32 s86, s80, 8192
    buffer_load_dwordx4 v6, s[32:35], s86 offen  lds
    s_add_u32 m0, s81, 12672
    s_add_u32 s86, s80, 12288
    buffer_load_dwordx4 v6, s[32:35], s86 offen  lds
    s_add_u32 m0, s81, 16896
    s_add_u32 s86, s80, 16384
    buffer_load_dwordx4 v6, s[32:35], s86 offen  lds
    s_add_u32 m0, s81, 21120
    s_add_u32 s86, s80, 20480
    buffer_load_dwordx4 v6, s[32:35], s86 offen  lds
    s_add_u32 m0, s81, 25344
    s_add_u32 s86, s80, 24576
    buffer_load_dwordx4 v6, s[32:35], s86 offen  lds
    s_add_u32 m0, s81, 29568
    s_add_u32 s86, s80, 28672
    buffer_load_dwordx4 v6, s[32:35], s86 offen  lds
    s_add_u32 m0, s81, 33792
    s_add_u32 s86, s80, 32768
    buffer_load_dwordx4 v6, s[32:35], s86 offen  lds
    s_add_u32 m0, s81, 38016
    s_add_u32 s86, s80, 36864
    buffer_load_dwordx4 v6, s[32:35], s86 offen  lds
    s_barrier
    s_add_u32 m0, s81, 42240
    s_add_u32 s86, s80, 40960
    buffer_load_dwordx4 v6, s[32:35], s86 offen  lds
    s_add_u32 m0, s81, 46464
    s_add_u32 s86, s80, 45056
    buffer_load_dwordx4 v6, s[32:35], s86 offen  lds
    s_add_u32 m0, s81, 50688
    s_add_u32 s86, s80, 49152
    buffer_load_dwordx4 v6, s[32:35], s86 offen  lds
    s_add_u32 m0, s81, 54912
    s_add_u32 s86, s80, 53248
    buffer_load_dwordx4 v6, s[32:35], s86 offen  lds
    s_add_u32 m0, s81, 59136
    s_add_u32 s86, s80, 57344
    buffer_load_dwordx4 v6, s[32:35], s86 offen  lds
    s_add_u32 m0, s81, 63360
    s_add_u32 s86, s80, 61440
    buffer_load_dwordx4 v6, s[32:35], s86 offen  lds
    s_barrier
    s_branch L_qgather
L_frontB:
    s_and_b32 s92, s69, 15
    s_lshl_b32 s93, s68, 10
    s_cmp_gt_u32 s70, 4
    s_cbranch_scc1 L_B2
    s_mul_i32 s89, s92, 5
    s_add_u32 s89, s89, s70
    s_lshl_b32 s89, s89, 16
    s_add_u32 s89, s89, s93
    s_add_u32 s89, s89, 32768
    buffer_load_dwordx4 v[16:19], v6, s[36:39], s89 offen
    s_add_u32 s89, s89, 8192
    buffer_load_dwordx4 v[16:19], v6, s[36:39], s89 offen
    s_add_u32 s89, s89, 8192
    buffer_load_dwordx4 v[16:19], v6, s[36:39], s89 offen
    s_add_u32 s89, s89, 8192
    buffer_load_dwordx4 v[16:19], v6, s[36:39], s89 offen
L_B2:
    s_lshl_b32 s91, s92, 3
    s_add_u32 s91, s91, s70
    s_lshl_b32 s91, s91, 15
    s_add_u32 s91, s91, s93
    s_barrier
    buffer_load_dwordx4 v[16:19], v6, s[40:43], s91 offen
    s_add_u32 s91, s91, 8192
    buffer_load_dwordx4 v[16:19], v6, s[40:43], s91 offen
    s_add_u32 s91, s91, 8192
    buffer_load_dwordx4 v[16:19], v6, s[40:43], s91 offen
    s_add_u32 s91, s91, 8192
    buffer_load_dwordx4 v[16:19], v6, s[40:43], s91 offen
L_B3:
    s_barrier
    s_add_u32 m0, s81, 0
    s_add_u32 s86, s80, 0
    buffer_load_dwordx4 v6, s[32:35], s86 offen  lds
    s_add_u32 m0, s81, 4224
    s_add_u32 s86, s80, 4096
    buffer_load_dwordx4 v6, s[32:35], s86 offen  lds
    s_add_u32 m0, s81, 8448
    s_add_u32 s86, s80, 8192
    buffer_load_dwordx4 v6, s[32:35], s86 offen  lds
    s_add_u32 m0, s81, 12672
    s_add_u32 s86, s80, 12288
    buffer_load_dwordx4 v6, s[32:35], s86 offen  lds
    s_add_u32 m0, s81, 16896
    s_add_u32 s86, s80, 16384
    buffer_load_dwordx4 v6, s[32:35], s86 offen  lds
    s_add_u32 m0, s81, 21120
    s_add_u32 s86, s80, 20480
    buffer_load_dwordx4 v6, s[32:35], s86 offen  lds
    s_add_u32 m0, s81, 25344
    s_add_u32 s86, s80, 24576
    buffer_load_dwordx4 v6, s[32:35], s86 offen  lds
    s_add_u32 m0, s81, 29568
    s_add_u32 s86, s80, 28672
    buffer_load_dwordx4 v6, s[32:35], s86 offen  lds
    s_add_u32 m0, s81, 33792
    s_add_u32 s86, s80, 32768
    buffer_load_dwordx4 v6, s[32:35], s86 offen  lds
    s_add_u32 m0, s81, 38016
    s_add_u32 s86, s80, 36864
    buffer_load_dwordx4 v6, s[32:35], s86 offen  lds
    s_add_u32 m0, s81, 42240
    s_add_u32 s86, s80, 40960
    buffer_load_dwordx4 v6, s[32:35], s86 offen  lds
    s_add_u32 m0, s81, 46464
    s_add_u32 s86, s80, 45056
    buffer_load_dwordx4 v6, s[32:35], s86 offen  lds
    s_add_u32 m0, s81, 50688
    s_add_u32 s86, s80, 49152
    buffer_load_dwordx4 v6, s[32:35], s86 offen  lds
    s_add_u32 m0, s81, 54912
    s_add_u32 s86, s80, 53248
    buffer_load_dwordx4 v6, s[32:35], s86 offen  lds
    s_add_u32 m0, s81, 59136
    s_add_u32 s86, s80, 57344
    buffer_load_dwordx4 v6, s[32:35], s86 offen  lds
    s_add_u32 m0, s81, 63360
    s_add_u32 s86, s80, 61440
    buffer_load_dwordx4 v6, s[32:35], s86 offen  lds
    s_waitcnt lgkmcnt(0)
    s_mul_i32 s72, s82, 0x9E3779B1
    s_add_u32 s72, s72, 0x7F4A7C15
    s_mul_i32 s73, s83, 0x2C9277B5
    s_add_u32 s73, s73, 0xAC564B05
    s_cmp_lg_u32 s70, 0
    s_cbranch_scc1 L_qgather
    s_getreg_b32 s84, hwreg(HW_REG_XCC_ID)
    s_and_b32 s84, s84, 15
    s_lshl_b32 s85, s68, 9
    s_add_u32 s85, s85, 4096
    s_lshl_b32 s86, s69, 4
    v_mov_b32 v40, s84
    v_mov_b32 v41, 0
    v_mov_b32 v42, s72
    v_mov_b32 v43, s73
    v_mov_b32 v12, s86
    s_mov_b64 exec, 1
    buffer_store_dwordx4 v[40:43], v12, s[64:67], s85 offen sc1
    s_mov_b64 exec, -1
    s_lshl_b32 s89, s77, 2
    s_add_u32 s89, s89, s79
    s_lshl_b32 s89, s89, 11
    s_add_u32 s89, s89, 2097152
    buffer_load_dwordx4 v[16:19], v6, s[64:67], s89 offen sc1
    buffer_load_dwordx4 v[16:19], v6, s[64:67], s89 offen offset:1024 sc1
    s_and_b32 s90, s69, 15
    s_lshl_b32 s90, s90, 10
    s_lshl_b32 s89, s68, 14
    s_add_u32 s89, s89, s90
    s_add_u32 s89, s89, 1441792
    buffer_load_dwordx4 v[16:19], v6, s[64:67], s89 offen sc1
    s_mul_i32 s89, s68, 10240
    s_min_u32 s90, s90, 9216
    s_add_u32 s89, s89, s90
    s_add_u32 s89, s89, 1703936
    buffer_load_dwordx4 v[16:19], v6, s[64:67], s89 offen sc1
    s_branch L_qgather
L_qgather:
    s_load_dwordx2 s[44:45], s[0:1], 32
    s_mov_b32 s46, 4194304
    s_mov_b32 s47, 0x00020000
    s_load_dwordx2 s[48:49], s[0:1], 40
    s_mov_b32 s50, 5242880
    s_mov_b32 s51, 0x00020000
    s_load_dwordx2 s[52:53], s[0:1], 56
    s_mov_b32 s54, 2211840
    s_mov_b32 s55, 0x00020000
    s_load_dwordx2 s[56:57], s[0:1], 64
    s_mov_b32 s58, 2211840
    s_mov_b32 s59, 0x00020000
    s_load_dwordx2 s[60:61], s[0:1], 72
    s_mov_b32 s62, 5120
    s_mov_b32 s63, 0x00020000
    s_lshl_b32 s89, s79, 5
    s_and_b32 s90, s69, 16
    s_add_u32 s89, s89, s90
    s_lshl_b32 s90, s70, 1
    s_add_u32 s89, s89, s90
    s_lshl_b32 s89, s89, 11
    s_add_u32 s89, s89, 1048576
    s_lshl_b32 s85, s68, 9
    s_add_u32 s85, s85, 4096
    v_lshlrev_b32 v248, 4, v2
    v_add_u32 v248, 156160, v248
    s_lshl_b32 s90, s70, 2
    v_add_u32 v249, s90, v248
    s_sub_u32 s94, 15, s69
    s_cmp_eq_u32 s69, 31
    s_cselect_b32 s94, 6, s94
    s_cmp_eq_u32 s69, 9
    s_cselect_b32 s94, 7, s94
    s_cmp_lt_u32 s94, 7
    s_mul_i32 s90, s68, 7
    s_cselect_b32 s94, s94, 99
    s_add_u32 s100, s94, s90
    s_cmp_lt_u32 s70, 5
    s_cselect_b32 s101, s100, 99
    v_lshrrev_b32 v10, 3, v0
    v_and_b32 v245, 0x70, v6
    v_mul_u32_u24 v244, 10240, v10
    v_add_u32 v244, v244, v245
    v_lshl_add_u32 v10, v10, 13, v245
    v_mul_u32_u24 v247, 10240, v1
    v_lshl_add_u32 v247, v2, 4, v247
    s_and_b32 s93, s69, 8
    s_lshl_b32 s93, s93, 5
    s_and_b32 s90, s70, 2
    s_lshl_b32 s90, s90, 6
    s_add_u32 s93, s93, s90
    s_and_b32 s90, s70, 4
    s_lshl_b32 s90, s90, 4
    s_add_u32 s93, s93, s90
    s_and_b32 s90, s70, 1
    s_lshl_b32 s90, s90, 3
    s_add_u32 s93, s93, s90
    s_lshl_b32 s93, s93, 13
    s_add_u32 s93, s93, s88
    s_and_b32 s90, s69, 4
    s_lshl_b32 s90, s90, 5
    s_add_u32 s93, s93, s90
    s_and_b32 s82, s72, 0x3fffffff
    s_not_b32 s90, s72
    s_lshl_b32 s90, s90, 2
    s_and_b32 s90, s90, 0xc0000000
    s_or_b32 s82, s82, s90
    s_mov_b32 s83, 0x00010001
    s_waitcnt vmcnt(16)
    v_mov_b32 v246, s82
    s_mov_b32 s84, 0x10000
    v_not_b32 v246, v246
    v_lshlrev_b32 v245, 3, v4
    v_lshrrev_b32 v252, v245, v246
    v_lshlrev_b32 v15, 15, v252
    v_and_b32 v252, 1, v252
    v_and_or_b32 v252, v15, s84, v252
    v_add_u32 v245, 2, v245
    v_lshrrev_b32 v253, v245, v246
    v_lshlrev_b32 v15, 15, v253
    v_and_b32 v253, 1, v253
    v_and_or_b32 v253, v15, s84, v253
    v_add_u32 v245, 2, v245
    v_lshrrev_b32 v254, v245, v246
    v_lshlrev_b32 v15, 15, v254
    v_and_b32 v254, 1, v254
    v_and_or_b32 v254, v15, s84, v254
    v_add_u32 v245, 2, v245
    v_lshrrev_b32 v255, v245, v246
    v_lshlrev_b32 v15, 15, v255
    v_and_b32 v255, 1, v255
    v_and_or_b32 v255, v15, s84, v255
    s_barrier
    buffer_load_dwordx4 v[144:147], v6, s[64:67], s89 offen offset:0 sc1
    buffer_load_dwordx4 v[148:151], v6, s[64:67], s89 offen offset:1024 sc1
    buffer_load_dwordx4 v[152:155], v6, s[64:67], s89 offen offset:2048 sc1
    buffer_load_dwordx4 v[156:159], v6, s[64:67], s89 offen offset:3072 sc1
    v_mul_u32_u24 v12, 1056, v2
    v_lshl_add_u32 v12, v1, 4, v12
    s_mul_i32 s90, s70, 33792
    v_add_u32 v11, s90, v12
    v_mul_u32_u24 v13, 1056, v5
    v_lshl_add_u32 v13, v4, 3, v13
    s_and_b32 s94, s70, 3
    s_lshl_b32 s90, s94, 8
    v_add_u32 v13, s90, v13
    v_add_u32 v14, 67584, v13
    v_lshlrev_b32 v8, 3, v0
    s_mul_i32 s90, s70, 2112
    s_add_u32 s90, s90, 135168
    v_add_u32 v8, s90, v8
    v_add_u32 v12, 135168, v12
    s_waitcnt vmcnt(4) lgkmcnt(0)
    s_barrier
    s_cmp_lt_u32 s69, 16
    s_cbranch_scc1 L_tlF
    s_cmp_lt_u32 s70, 4
    s_cbranch_scc1 L_tlD
    buffer_load_dwordx4 v[212:215], v10, s[44:47], s93 offen nt
    s_add_u32 s93, s93, 131072
    buffer_load_dwordx4 v[216:219], v10, s[44:47], s93 offen nt
    s_add_u32 s93, s93, 131072
    buffer_load_dwordx4 v[220:223], v10, s[44:47], s93 offen nt
    s_add_u32 s93, s93, 131072
    buffer_load_dwordx4 v[224:227], v10, s[44:47], s93 offen nt
    s_branch L_tlD
L_tlF:
    s_cmp_lt_u32 s69, 10
    s_cbranch_scc0 L_tlF2
    s_lshl_b32 s91, s68, 3
    s_add_u32 s91, s91, s70
    s_mul_i32 s91, s91, 81920
    s_lshl_b32 s90, s69, 7
    s_add_u32 s91, s91, s90
    buffer_load_dwordx4 v[212:215], v244, s[48:51], s91 offen offset:0 nt
    buffer_load_dwordx4 v[216:219], v244, s[48:51], s91 offen offset:1280 nt
    buffer_load_dwordx4 v[220:223], v244, s[48:51], s91 offen offset:2560 nt
    buffer_load_dwordx4 v[224:227], v244, s[48:51], s91 offen offset:3840 nt
    s_branch L_tlD
L_tlF2:
    s_mul_i32 s91, s101, 40960
    s_lshl_b32 s90, s70, 8
    s_add_u32 s91, s91, s90
    buffer_load_dwordx4 v[212:215], v247, s[56:59], s91 offen offset:0 nt
    buffer_load_dwordx4 v[216:219], v247, s[56:59], s91 offen offset:1280 nt
    buffer_load_dwordx4 v[220:223], v247, s[56:59], s91 offen offset:2560 nt
    buffer_load_dwordx4 v[224:227], v247, s[56:59], s91 offen offset:3840 nt
L_tlD:
    s_cmp_lt_u32 s70, 4
    s_cbranch_scc0 L_opV
    ds_read_b128 v[16:19], v11 offset:0
    ds_read_b128 v[20:23], v11 offset:64
    ds_read_b128 v[24:27], v11 offset:128
    ds_read_b128 v[28:31], v11 offset:192
    ds_read_b128 v[32:35], v11 offset:256
    ds_read_b128 v[36:39], v11 offset:320
    ds_read_b128 v[40:43], v11 offset:384
    ds_read_b128 v[44:47], v11 offset:448
    ds_read_b128 v[48:51], v11 offset:512
    ds_read_b128 v[52:55], v11 offset:576
    ds_read_b128 v[56:59], v11 offset:640
    ds_read_b128 v[60:63], v11 offset:704
    ds_read_b128 v[64:67], v11 offset:768
    ds_read_b128 v[68:71], v11 offset:832
    ds_read_b128 v[72:75], v11 offset:896
    ds_read_b128 v[76:79], v11 offset:960
    ds_read_b128 v[80:83], v11 offset:16896
    ds_read_b128 v[84:87], v11 offset:16960
    ds_read_b128 v[88:91], v11 offset:17024
    ds_read_b128 v[92:95], v11 offset:17088
    ds_read_b128 v[96:99], v11 offset:17152
    ds_read_b128 v[100:103], v11 offset:17216
    ds_read_b128 v[104:107], v11 offset:17280
    ds_read_b128 v[108:111], v11 offset:17344
    ds_read_b128 v[112:115], v11 offset:17408
    ds_read_b128 v[116:119], v11 offset:17472
    ds_read_b128 v[120:123], v11 offset:17536
    ds_read_b128 v[124:127], v11 offset:17600
    ds_read_b128 v[128:131], v11 offset:17664
    ds_read_b128 v[132:135], v11 offset:17728
    ds_read_b128 v[136:139], v11 offset:17792
    ds_read_b128 v[140:143], v11 offset:17856
    s_branch L_opD
L_opV:
    ds_read_b64_tr_b16 v[16:17], v13 offset:0
    ds_read_b64_tr_b16 v[18:19], v13 offset:16896
    ds_read_b64_tr_b16 v[20:21], v13 offset:32
    ds_read_b64_tr_b16 v[22:23], v13 offset:16928
    ds_read_b64_tr_b16 v[24:25], v13 offset:64
    ds_read_b64_tr_b16 v[26:27], v13 offset:16960
    ds_read_b64_tr_b16 v[28:29], v13 offset:96
    ds_read_b64_tr_b16 v[30:31], v13 offset:16992
    ds_read_b64_tr_b16 v[32:33], v13 offset:128
    ds_read_b64_tr_b16 v[34:35], v13 offset:17024
    ds_read_b64_tr_b16 v[36:37], v13 offset:160
    ds_read_b64_tr_b16 v[38:39], v13 offset:17056
L_opD:
    s_cmp_lt_u32 s69, 16
    s_cbranch_scc1 L_qw4
    s_cmp_lt_u32 s70, 4
    s_cbranch_scc0 L_qw4
    s_waitcnt vmcnt(0)
L_qw4:
    s_waitcnt vmcnt(4)
    v_cmp_ne_u64 vcc, s[72:73], v[146:147]
    v_cmp_ne_u64 s[98:99], s[72:73], v[150:151]
    s_or_b64 vcc, vcc, s[98:99]
    v_cmp_ne_u64 s[98:99], s[72:73], v[154:155]
    s_or_b64 vcc, vcc, s[98:99]
    v_cmp_ne_u64 s[98:99], s[72:73], v[158:159]
    s_or_b64 vcc, vcc, s[98:99]
    s_cbranch_vccz L_qok
Lpoll_1:
    buffer_load_dwordx4 v[144:147], v6, s[64:67], s89 offen offset:0 sc1
    buffer_load_dwordx4 v[148:151], v6, s[64:67], s89 offen offset:1024 sc1
    buffer_load_dwordx4 v[152:155], v6, s[64:67], s89 offen offset:2048 sc1
    buffer_load_dwordx4 v[156:159], v6, s[64:67], s89 offen offset:3072 sc1
    s_add_u32 s76, s76, 1
    s_cmp_gt_u32 s76, 400000
    s_cbranch_scc1 L_end
    s_waitcnt vmcnt(0)
    v_cmp_ne_u64 vcc, s[72:73], v[146:147]
    v_cmp_ne_u64 s[98:99], s[72:73], v[150:151]
    s_or_b64 vcc, vcc, s[98:99]
    v_cmp_ne_u64 s[98:99], s[72:73], v[154:155]
    s_or_b64 vcc, vcc, s[98:99]
    v_cmp_ne_u64 s[98:99], s[72:73], v[158:159]
    s_or_b64 vcc, vcc, s[98:99]
    s_cbranch_vccnz Lpoll_1
L_qok:
    ds_write_b64 v8, v[144:145] offset:0
    ds_write_b64 v8, v[148:149] offset:512
    ds_write_b64 v8, v[152:153] offset:1056
    ds_write_b64 v8, v[156:157] offset:1568
    s_waitcnt lgkmcnt(0)
    s_barrier
    v_mov_b32 v234, s72
    v_mov_b32 v235, s73
    v_mov_b32 v238, s72
    v_mov_b32 v239, s73
    s_cmp_lt_u32 s70, 4
    s_cbranch_scc0 L_V
    ds_read_b128 v[144:147], v12 offset:0
    ds_read_b128 v[148:151], v12 offset:64
    ds_read_b128 v[152:155], v12 offset:128
    ds_read_b128 v[156:159], v12 offset:192
    ds_read_b128 v[160:163], v12 offset:256
    ds_read_b128 v[164:167], v12 offset:320
    ds_read_b128 v[168:171], v12 offset:384
    ds_read_b128 v[172:175], v12 offset:448
    ds_read_b128 v[176:179], v12 offset:512
    ds_read_b128 v[180:183], v12 offset:576
    ds_read_b128 v[184:187], v12 offset:640
    ds_read_b128 v[188:191], v12 offset:704
    ds_read_b128 v[192:195], v12 offset:768
    ds_read_b128 v[196:199], v12 offset:832
    ds_read_b128 v[200:203], v12 offset:896
    ds_read_b128 v[204:207], v12 offset:960
    s_cmp_lt_u32 s69, 16
    s_cbranch_scc1 L_nouv
    buffer_load_dwordx4 v[212:215], v10, s[44:47], s93 offen nt
    s_add_u32 s93, s93, 131072
    buffer_load_dwordx4 v[216:219], v10, s[44:47], s93 offen nt
    s_add_u32 s93, s93, 131072
    buffer_load_dwordx4 v[220:223], v10, s[44:47], s93 offen nt
    s_add_u32 s93, s93, 131072
    buffer_load_dwordx4 v[224:227], v10, s[44:47], s93 offen nt
L_nouv:
    s_waitcnt lgkmcnt(15)
    v_mfma_f32_16x16x32_bf16 v[228:231], v[16:19], v[144:147], 0
    v_mfma_f32_16x16x32_bf16 v[208:211], v[80:83], v[144:147], 0
    s_waitcnt lgkmcnt(14)
    v_mfma_f32_16x16x32_bf16 v[228:231], v[20:23], v[148:151], v[228:231]
    v_mfma_f32_16x16x32_bf16 v[208:211], v[84:87], v[148:151], v[208:211]
    s_waitcnt lgkmcnt(13)
    v_mfma_f32_16x16x32_bf16 v[228:231], v[24:27], v[152:155], v[228:231]
    v_mfma_f32_16x16x32_bf16 v[208:211], v[88:91], v[152:155], v[208:211]
    s_waitcnt lgkmcnt(12)
    v_mfma_f32_16x16x32_bf16 v[228:231], v[28:31], v[156:159], v[228:231]
    v_mfma_f32_16x16x32_bf16 v[208:211], v[92:95], v[156:159], v[208:211]
    s_waitcnt lgkmcnt(11)
    v_mfma_f32_16x16x32_bf16 v[228:231], v[32:35], v[160:163], v[228:231]
    v_mfma_f32_16x16x32_bf16 v[208:211], v[96:99], v[160:163], v[208:211]
    s_waitcnt lgkmcnt(10)
    v_mfma_f32_16x16x32_bf16 v[228:231], v[36:39], v[164:167], v[228:231]
    v_mfma_f32_16x16x32_bf16 v[208:211], v[100:103], v[164:167], v[208:211]
    s_waitcnt lgkmcnt(9)
    v_mfma_f32_16x16x32_bf16 v[228:231], v[40:43], v[168:171], v[228:231]
    v_mfma_f32_16x16x32_bf16 v[208:211], v[104:107], v[168:171], v[208:211]
    s_waitcnt lgkmcnt(8)
    v_mfma_f32_16x16x32_bf16 v[228:231], v[44:47], v[172:175], v[228:231]
    v_mfma_f32_16x16x32_bf16 v[208:211], v[108:111], v[172:175], v[208:211]
    s_waitcnt lgkmcnt(7)
    v_mfma_f32_16x16x32_bf16 v[228:231], v[48:51], v[176:179], v[228:231]
    v_mfma_f32_16x16x32_bf16 v[208:211], v[112:115], v[176:179], v[208:211]
    s_waitcnt lgkmcnt(6)
    v_mfma_f32_16x16x32_bf16 v[228:231], v[52:55], v[180:183], v[228:231]
    v_mfma_f32_16x16x32_bf16 v[208:211], v[116:119], v[180:183], v[208:211]
    s_waitcnt lgkmcnt(5)
    v_mfma_f32_16x16x32_bf16 v[228:231], v[56:59], v[184:187], v[228:231]
    v_mfma_f32_16x16x32_bf16 v[208:211], v[120:123], v[184:187], v[208:211]
    s_waitcnt lgkmcnt(4)
    v_mfma_f32_16x16x32_bf16 v[228:231], v[60:63], v[188:191], v[228:231]
    v_mfma_f32_16x16x32_bf16 v[208:211], v[124:127], v[188:191], v[208:211]
    s_waitcnt lgkmcnt(3)
    v_mfma_f32_16x16x32_bf16 v[228:231], v[64:67], v[192:195], v[228:231]
    v_mfma_f32_16x16x32_bf16 v[208:211], v[128:131], v[192:195], v[208:211]
    s_waitcnt lgkmcnt(2)
    v_mfma_f32_16x16x32_bf16 v[228:231], v[68:71], v[196:199], v[228:231]
    v_mfma_f32_16x16x32_bf16 v[208:211], v[132:135], v[196:199], v[208:211]
    s_waitcnt lgkmcnt(1)
    v_mfma_f32_16x16x32_bf16 v[228:231], v[72:75], v[200:203], v[228:231]
    v_mfma_f32_16x16x32_bf16 v[208:211], v[136:139], v[200:203], v[208:211]
    s_waitcnt lgkmcnt(0)
    v_mfma_f32_16x16x32_bf16 v[228:231], v[76:79], v[204:207], v[228:231]
    v_mfma_f32_16x16x32_bf16 v[208:211], v[140:143], v[204:207], v[208:211]
    s_lshl_b32 s90, s70, 10
    s_add_u32 s90, s90, 152064
    v_add_u32 v12, s90, v6
    s_nop 3
    v_max3_f32 v232, v228, v229, v230
    s_nop 0
    v_max3_f32 v233, v231, v208, v209
    v_max3_f32 v232, v232, v210, v211
    v_max_f32 v232, v232, v233
    v_mov_b32 v233, v232
    s_nop 1
    v_permlane16_swap_b32 v232, v233
    s_nop 0
    v_max_f32 v232, v232, v233
    v_mov_b32 v233, v232
    s_nop 1
    v_permlane32_swap_b32 v232, v233
    s_nop 0
    v_max_f32 v232, v232, v233
    ds_write_b32 v249, v232
    s_waitcnt lgkmcnt(0)
    s_barrier
    ds_read_b128 v[240:243], v248
    s_waitcnt lgkmcnt(0)
    v_max3_f32 v232, v240, v241, v242
    v_max_f32 v232, v232, v243
    v_mul_f32 v232, 0x3e0293ee, v232
    s_mov_b32 s90, 0x3e0293ee
    v_fma_f32 v228, v228, s90, -v232
    v_fma_f32 v229, v229, s90, -v232
    v_fma_f32 v230, v230, s90, -v232
    v_fma_f32 v231, v231, s90, -v232
    v_fma_f32 v208, v208, s90, -v232
    v_fma_f32 v209, v209, s90, -v232
    v_fma_f32 v210, v210, s90, -v232
    v_fma_f32 v211, v211, s90, -v232
    v_exp_f32 v228, v228
    v_exp_f32 v229, v229
    v_exp_f32 v230, v230
    v_exp_f32 v231, v231
    v_exp_f32 v208, v208
    v_exp_f32 v209, v209
    v_exp_f32 v210, v210
    v_exp_f32 v211, v211
    v_cvt_pk_bf16_f32 v240, v228, v229
    v_cvt_pk_bf16_f32 v241, v230, v231
    v_cvt_pk_bf16_f32 v242, v208, v209
    v_cvt_pk_bf16_f32 v243, v210, v211
    ds_write_b128 v12, v[240:243]
    s_waitcnt lgkmcnt(0)
    s_barrier
    s_cmp_lg_u32 s70, 3
    s_cbranch_scc1 L_cbK
    v_add_u32 v11, 152064, v6
    ds_read_b128 v[144:147], v11 offset:0
    ds_read_b128 v[148:151], v11 offset:1024
    ds_read_b128 v[152:155], v11 offset:2048
    ds_read_b128 v[156:159], v11 offset:3072
    v_mov_b32 v240, 0x3f803f80
    v_mov_b32 v241, 0x3f803f80
    v_mov_b32 v242, 0x3f803f80
    v_mov_b32 v243, 0x3f803f80
    s_lshl_b32 s95, s79, 5
    s_and_b32 s90, s69, 16
    s_add_u32 s95, s95, s90
    s_lshl_b32 s95, s95, 1
    s_add_u32 s95, s95, s77
    s_lshl_b32 s95, s95, 8
    s_add_u32 s95, s95, 1376256
    s_waitcnt lgkmcnt(3)
    v_mfma_f32_16x16x32_bf16 v[228:231], v[240:243], v[144:147], 0
    s_waitcnt lgkmcnt(2)
    v_mfma_f32_16x16x32_bf16 v[228:231], v[240:243], v[148:151], v[228:231]
    s_waitcnt lgkmcnt(1)
    v_mfma_f32_16x16x32_bf16 v[228:231], v[240:243], v[152:155], v[228:231]
    s_waitcnt lgkmcnt(0)
    v_mfma_f32_16x16x32_bf16 v[228:231], v[240:243], v[156:159], v[228:231]
    s_nop 7
    v_mov_b32 v233, v228
    s_mov_b32 exec_lo, 0xffff
    s_mov_b32 exec_hi, 0x0
    buffer_store_dwordx4 v[232:235], v6, s[64:67], s95 offen sc1
    s_mov_b64 exec, -1
    s_branch L_cbK
L_V:
    s_cmp_lt_u32 s69, 16
    s_cbranch_scc0 L_f2xv
    s_add_u32 s90, s91, 5120
    s_cmp_lt_u32 s69, 10
    s_cbranch_scc0 L_f2bv
    buffer_load_dwordx4 v[192:195], v244, s[48:51], s90 offen offset:0 nt
    buffer_load_dwordx4 v[196:199], v244, s[48:51], s90 offen offset:1280 nt
    buffer_load_dwordx4 v[200:203], v244, s[48:51], s90 offen offset:2560 nt
    buffer_load_dwordx4 v[204:207], v244, s[48:51], s90 offen offset:3840 nt
    s_branch L_f2xv
L_f2bv:
    buffer_load_dwordx4 v[192:195], v247, s[56:59], s90 offen offset:0 nt
    buffer_load_dwordx4 v[196:199], v247, s[56:59], s90 offen offset:1280 nt
    buffer_load_dwordx4 v[200:203], v247, s[56:59], s90 offen offset:2560 nt
    buffer_load_dwordx4 v[204:207], v247, s[56:59], s90 offen offset:3840 nt
L_f2xv:
    ds_read_b64_tr_b16 v[40:41], v13 offset:192
    ds_read_b64_tr_b16 v[42:43], v13 offset:17088
    ds_read_b64_tr_b16 v[44:45], v13 offset:224
    ds_read_b64_tr_b16 v[46:47], v13 offset:17120
    ds_read_b64_tr_b16 v[48:49], v13 offset:33792
    ds_read_b64_tr_b16 v[50:51], v13 offset:50688
    ds_read_b64_tr_b16 v[52:53], v13 offset:33824
    ds_read_b64_tr_b16 v[54:55], v13 offset:50720
    ds_read_b64_tr_b16 v[56:57], v13 offset:33856
    ds_read_b64_tr_b16 v[58:59], v13 offset:50752
    ds_read_b64_tr_b16 v[60:61], v13 offset:33888
    ds_read_b64_tr_b16 v[62:63], v13 offset:50784
    ds_read_b64_tr_b16 v[64:65], v13 offset:33920
    ds_read_b64_tr_b16 v[66:67], v13 offset:50816
    ds_read_b64_tr_b16 v[68:69], v13 offset:33952
    ds_read_b64_tr_b16 v[70:71], v13 offset:50848
    ds_read_b64_tr_b16 v[72:73], v13 offset:33984
    ds_read_b64_tr_b16 v[74:75], v13 offset:50880
    ds_read_b64_tr_b16 v[76:77], v13 offset:34016
    ds_read_b64_tr_b16 v[78:79], v13 offset:50912
    ds_read_b64_tr_b16 v[80:81], v14 offset:0
    ds_read_b64_tr_b16 v[82:83], v14 offset:16896
    ds_read_b64_tr_b16 v[84:85], v14 offset:32
    ds_read_b64_tr_b16 v[86:87], v14 offset:16928
    ds_read_b64_tr_b16 v[88:89], v14 offset:64
    ds_read_b64_tr_b16 v[90:91], v14 offset:16960
    ds_read_b64_tr_b16 v[92:93], v14 offset:96
    ds_read_b64_tr_b16 v[94:95], v14 offset:16992
    ds_read_b64_tr_b16 v[96:97], v14 offset:128
    ds_read_b64_tr_b16 v[98:99], v14 offset:17024
    ds_read_b64_tr_b16 v[100:101], v14 offset:160
    ds_read_b64_tr_b16 v[102:103], v14 offset:17056
    ds_read_b64_tr_b16 v[104:105], v14 offset:192
    ds_read_b64_tr_b16 v[106:107], v14 offset:17088
    ds_read_b64_tr_b16 v[108:109], v14 offset:224
    ds_read_b64_tr_b16 v[110:111], v14 offset:17120
    ds_read_b64_tr_b16 v[112:113], v14 offset:33792
    ds_read_b64_tr_b16 v[114:115], v14 offset:50688
    ds_read_b64_tr_b16 v[116:117], v14 offset:33824
    ds_read_b64_tr_b16 v[118:119], v14 offset:50720
    ds_read_b64_tr_b16 v[120:121], v14 offset:33856
    ds_read_b64_tr_b16 v[122:123], v14 offset:50752
    ds_read_b64_tr_b16 v[124:125], v14 offset:33888
    ds_read_b64_tr_b16 v[126:127], v14 offset:50784
    ds_read_b64_tr_b16 v[128:129], v14 offset:33920
    ds_read_b64_tr_b16 v[130:131], v14 offset:50816
    ds_read_b64_tr_b16 v[132:133], v14 offset:33952
    ds_read_b64_tr_b16 v[134:135], v14 offset:50848
    ds_read_b64_tr_b16 v[136:137], v14 offset:33984
    ds_read_b64_tr_b16 v[138:139], v14 offset:50880
    ds_read_b64_tr_b16 v[140:141], v14 offset:34016
    ds_read_b64_tr_b16 v[142:143], v14 offset:50912
    v_lshlrev_b32 v13, 17, v1
    v_lshl_add_u32 v13, v2, 4, v13
    s_lshl_b32 s93, s79, 5
    s_and_b32 s90, s69, 16
    s_add_u32 s93, s93, s90
    s_lshl_b32 s93, s93, 15
    s_lshl_b32 s90, s77, 10
    s_add_u32 s93, s93, s90
    s_lshl_b32 s90, s94, 8
    s_add_u32 s93, s93, s90
    s_add_u32 s93, s93, 4194304
    v_add_u32 v11, 152064, v6
    v_xor_b32 v208, s83, v252
    v_xor_b32 v209, s83, v253
    v_xor_b32 v210, s83, v254
    v_xor_b32 v211, s83, v255
    s_barrier
    s_waitcnt lgkmcnt(0)
    s_barrier
    ds_read_b128 v[144:147], v11 offset:0
    ds_read_b128 v[148:151], v11 offset:1024
    ds_read_b128 v[152:155], v11 offset:2048
    ds_read_b128 v[156:159], v11 offset:3072
    s_waitcnt lgkmcnt(3)
    v_mfma_f32_16x16x32_bf16 v[160:163], v[144:147], v[16:19], 0
    v_mfma_f32_16x16x32_bf16 v[164:167], v[144:147], v[20:23], 0
    v_mfma_f32_16x16x32_bf16 v[168:171], v[144:147], v[24:27], 0
    v_mfma_f32_16x16x32_bf16 v[172:175], v[144:147], v[28:31], 0
    v_mfma_f32_16x16x32_bf16 v[176:179], v[144:147], v[32:35], 0
    v_mfma_f32_16x16x32_bf16 v[180:183], v[144:147], v[36:39], 0
    v_mfma_f32_16x16x32_bf16 v[184:187], v[144:147], v[40:43], 0
    v_mfma_f32_16x16x32_bf16 v[188:191], v[144:147], v[44:47], 0
    s_waitcnt lgkmcnt(2)
    v_mfma_f32_16x16x32_bf16 v[160:163], v[148:151], v[48:51], v[160:163]
    v_mfma_f32_16x16x32_bf16 v[164:167], v[148:151], v[52:55], v[164:167]
    v_mfma_f32_16x16x32_bf16 v[168:171], v[148:151], v[56:59], v[168:171]
    v_mfma_f32_16x16x32_bf16 v[172:175], v[148:151], v[60:63], v[172:175]
    v_mfma_f32_16x16x32_bf16 v[176:179], v[148:151], v[64:67], v[176:179]
    v_mfma_f32_16x16x32_bf16 v[180:183], v[148:151], v[68:71], v[180:183]
    v_mfma_f32_16x16x32_bf16 v[184:187], v[148:151], v[72:75], v[184:187]
    v_mfma_f32_16x16x32_bf16 v[188:191], v[148:151], v[76:79], v[188:191]
    s_waitcnt lgkmcnt(1)
    v_mfma_f32_16x16x32_bf16 v[160:163], v[152:155], v[80:83], v[160:163]
    v_mfma_f32_16x16x32_bf16 v[164:167], v[152:155], v[84:87], v[164:167]
    v_mfma_f32_16x16x32_bf16 v[168:171], v[152:155], v[88:91], v[168:171]
    v_mfma_f32_16x16x32_bf16 v[172:175], v[152:155], v[92:95], v[172:175]
    v_mfma_f32_16x16x32_bf16 v[176:179], v[152:155], v[96:99], v[176:179]
    v_mfma_f32_16x16x32_bf16 v[180:183], v[152:155], v[100:103], v[180:183]
    v_mfma_f32_16x16x32_bf16 v[184:187], v[152:155], v[104:107], v[184:187]
    v_mfma_f32_16x16x32_bf16 v[188:191], v[152:155], v[108:111], v[188:191]
    s_waitcnt lgkmcnt(0)
    v_mfma_f32_16x16x32_bf16 v[160:163], v[156:159], v[112:115], v[160:163]
    v_mfma_f32_16x16x32_bf16 v[164:167], v[156:159], v[116:119], v[164:167]
    v_mfma_f32_16x16x32_bf16 v[168:171], v[156:159], v[120:123], v[168:171]
    v_mfma_f32_16x16x32_bf16 v[172:175], v[156:159], v[124:127], v[172:175]
    v_mfma_f32_16x16x32_bf16 v[176:179], v[156:159], v[128:131], v[176:179]
    v_mfma_f32_16x16x32_bf16 v[180:183], v[156:159], v[132:135], v[180:183]
    v_mfma_f32_16x16x32_bf16 v[184:187], v[156:159], v[136:139], v[184:187]
    v_mfma_f32_16x16x32_bf16 v[188:191], v[156:159], v[140:143], v[188:191]
    s_nop 5
    v_perm_b32 v16, v164, v160, s75
    v_perm_b32 v17, v172, v168, s75
    v_perm_b32 v18, v180, v176, s75
    v_perm_b32 v19, v188, v184, s75
    v_bfi_b32 v16, s83, v208, v16
    v_bfi_b32 v17, s83, v209, v17
    v_bfi_b32 v18, s83, v210, v18
    v_bfi_b32 v19, s83, v211, v19
    buffer_store_dwordx4 v[16:19], v13, s[64:67], s93 offen sc1
    s_add_u32 s93, s93, 32768
    v_perm_b32 v20, v165, v161, s75
    v_perm_b32 v21, v173, v169, s75
    v_perm_b32 v22, v181, v177, s75
    v_perm_b32 v23, v189, v185, s75
    v_bfi_b32 v20, s83, v208, v20
    v_bfi_b32 v21, s83, v209, v21
    v_bfi_b32 v22, s83, v210, v22
    v_bfi_b32 v23, s83, v211, v23
    buffer_store_dwordx4 v[20:23], v13, s[64:67], s93 offen sc1
    s_add_u32 s93, s93, 32768
    v_perm_b32 v24, v166, v162, s75
    v_perm_b32 v25, v174, v170, s75
    v_perm_b32 v26, v182, v178, s75
    v_perm_b32 v27, v190, v186, s75
    v_bfi_b32 v24, s83, v208, v24
    v_bfi_b32 v25, s83, v209, v25
    v_bfi_b32 v26, s83, v210, v26
    v_bfi_b32 v27, s83, v211, v27
    buffer_store_dwordx4 v[24:27], v13, s[64:67], s93 offen sc1
    s_add_u32 s93, s93, 32768
    v_perm_b32 v28, v167, v163, s75
    v_perm_b32 v29, v175, v171, s75
    v_perm_b32 v30, v183, v179, s75
    v_perm_b32 v31, v191, v187, s75
    v_bfi_b32 v28, s83, v208, v28
    v_bfi_b32 v29, s83, v209, v29
    v_bfi_b32 v30, s83, v210, v30
    v_bfi_b32 v31, s83, v211, v31
    buffer_store_dwordx4 v[28:31], v13, s[64:67], s93 offen sc1
    s_barrier
    v_and_b32 v76, 0x1ff, v6
Lpoll_2:
    buffer_load_dwordx4 v[72:75], v76, s[64:67], s85 offen sc1
    s_add_u32 s76, s76, 1
    s_cmp_gt_u32 s76, 400000
    s_cbranch_scc1 L_end
    s_waitcnt vmcnt(0)
    v_cmp_ne_u64 vcc, s[72:73], v[74:75]
    s_cbranch_vccnz Lpoll_2
    s_getreg_b32 s84, hwreg(HW_REG_XCC_ID)
    s_and_b32 s84, s84, 15
    v_cmp_ne_u32 vcc, s84, v72
    s_cmp_eq_u64 vcc, 0
    s_cselect_b32 s71, 1, 0
    v_lshlrev_b32 v68, 11, v3
    v_lshl_add_u32 v68, v1, 5, v68
    v_and_b32 v69, 1, v0
    v_lshl_add_u32 v68, v69, 4, v68
    s_lshl_b32 s80, s77, 13
    s_and_b32 s90, s69, 8
    s_lshl_b32 s90, s90, 7
    s_add_u32 s80, s80, s90
    s_lshl_b32 s90, s70, 7
    s_add_u32 s80, s80, s90
    s_add_u32 s80, s80, 2097152
    v_and_b32 v70, 7, v0
    v_lshlrev_b32 v70, 5, v70
    v_lshl_add_u32 v70, v1, 8, v70
    s_lshl_b32 s90, s70, 10
    s_add_u32 s90, s90, 0
    v_add_u32 v70, s90, v70
    v_lshlrev_b32 v71, 11, v1
    v_lshl_add_u32 v71, v2, 4, v71
    s_lshl_b32 s81, s68, 14
    s_and_b32 s90, s69, 8
    s_lshl_b32 s90, s90, 10
    s_add_u32 s81, s81, s90
    s_and_b32 s90, s77, 3
    s_lshl_b32 s90, s90, 9
    s_add_u32 s81, s81, s90
    s_and_b32 s90, s69, 4
    s_lshl_b32 s90, s90, 6
    s_add_u32 s81, s81, s90
    s_add_u32 s81, s81, 1441792
    v_perm_b32 v80, v216, v212, s74
    v_perm_b32 v81, v224, v220, s74
    v_perm_b32 v82, v216, v212, s75
    v_perm_b32 v83, v224, v220, s75
    v_perm_b32 v84, v217, v213, s74
    v_perm_b32 v85, v225, v221, s74
    v_perm_b32 v86, v217, v213, s75
    v_perm_b32 v87, v225, v221, s75
    v_perm_b32 v88, v218, v214, s74
    v_perm_b32 v89, v226, v222, s74
    v_perm_b32 v90, v218, v214, s75
    v_perm_b32 v91, v226, v222, s75
    v_perm_b32 v92, v219, v215, s74
    v_perm_b32 v93, v227, v223, s74
    v_perm_b32 v94, v219, v215, s75
    v_perm_b32 v95, v227, v223, s75
    s_barrier
    s_branch L_cbd
L_cbK:
    s_barrier
    v_and_b32 v76, 0x1ff, v6
Lpoll_3:
    buffer_load_dwordx4 v[72:75], v76, s[64:67], s85 offen sc1
    s_add_u32 s76, s76, 1
    s_cmp_gt_u32 s76, 400000
    s_cbranch_scc1 L_end
    s_waitcnt vmcnt(0)
    v_cmp_ne_u64 vcc, s[72:73], v[74:75]
    s_cbranch_vccnz Lpoll_3
    s_getreg_b32 s84, hwreg(HW_REG_XCC_ID)
    s_and_b32 s84, s84, 15
    v_cmp_ne_u32 vcc, s84, v72
    s_cmp_eq_u64 vcc, 0
    s_cselect_b32 s71, 1, 0
    v_lshlrev_b32 v68, 11, v3
    v_lshl_add_u32 v68, v1, 5, v68
    v_and_b32 v69, 1, v0
    v_lshl_add_u32 v68, v69, 4, v68
    s_lshl_b32 s80, s77, 13
    s_and_b32 s90, s69, 8
    s_lshl_b32 s90, s90, 7
    s_add_u32 s80, s80, s90
    s_lshl_b32 s90, s70, 7
    s_add_u32 s80, s80, s90
    s_add_u32 s80, s80, 2097152
    v_and_b32 v70, 7, v0
    v_lshlrev_b32 v70, 5, v70
    v_lshl_add_u32 v70, v1, 8, v70
    s_lshl_b32 s90, s70, 10
    s_add_u32 s90, s90, 0
    v_add_u32 v70, s90, v70
    v_lshlrev_b32 v71, 11, v1
    v_lshl_add_u32 v71, v2, 4, v71
    s_lshl_b32 s81, s68, 14
    s_and_b32 s90, s69, 8
    s_lshl_b32 s90, s90, 10
    s_add_u32 s81, s81, s90
    s_and_b32 s90, s77, 3
    s_lshl_b32 s90, s90, 9
    s_add_u32 s81, s81, s90
    s_and_b32 s90, s69, 4
    s_lshl_b32 s90, s90, 6
    s_add_u32 s81, s81, s90
    s_add_u32 s81, s81, 1441792
    v_perm_b32 v80, v216, v212, s74
    v_perm_b32 v81, v224, v220, s74
    v_perm_b32 v82, v216, v212, s75
    v_perm_b32 v83, v224, v220, s75
    v_perm_b32 v84, v217, v213, s74
    v_perm_b32 v85, v225, v221, s74
    v_perm_b32 v86, v217, v213, s75
    v_perm_b32 v87, v225, v221, s75
    v_perm_b32 v88, v218, v214, s74
    v_perm_b32 v89, v226, v222, s74
    v_perm_b32 v90, v218, v214, s75
    v_perm_b32 v91, v226, v222, s75
    v_perm_b32 v92, v219, v215, s74
    v_perm_b32 v93, v227, v223, s74
    v_perm_b32 v94, v219, v215, s75
    v_perm_b32 v95, v227, v223, s75
    v_lshrrev_b32 v13, 5, v0
    v_and_b32 v9, 0x1ff, v6
    v_lshl_add_u32 v9, v13, 10, v9
    s_lshl_b32 s96, s79, 5
    s_add_u32 s96, s96, s77
    s_lshl_b32 s96, s96, 15
    s_lshl_b32 s90, s70, 13
    s_add_u32 s96, s96, s90
    s_and_b32 s90, s69, 16
    s_lshl_b32 s90, s90, 5
    s_add_u32 s96, s96, s90
    s_add_u32 s96, s96, 4194304
    s_add_u32 s92, s96, 4096
    v_lshl_add_u32 v12, v4, 1, v13
    v_lshlrev_b32 v12, 8, v12
    s_lshl_b32 s86, s79, 5
    s_and_b32 s90, s77, 16
    s_add_u32 s86, s86, s90
    s_lshl_b32 s86, s86, 9
    s_lshl_b32 s90, s70, 11
    s_add_u32 s86, s86, s90
    s_and_b32 s90, s77, 15
    s_lshl_b32 s90, s90, 4
    s_add_u32 s86, s86, s90
    s_add_u32 s86, s86, 1376256
    s_lshl_b32 s90, s70, 10
    s_add_u32 s90, s90, 49152
    v_add_u32 v11, s90, v6
    s_lshl_b32 s90, s70, 3
    s_add_u32 s90, s90, 57344
    v_mov_b32 v8, s90
    v_add_u32 v65, 49152, v6
    v_mov_b32 v66, 57344
    s_lshl_b32 s93, s77, 2
    s_add_u32 s93, s93, s79
    s_lshl_b32 s93, s93, 11
    s_and_b32 s90, s69, 16
    s_lshl_b32 s90, s90, 6
    s_add_u32 s93, s93, s90
    s_add_u32 s93, s93, 2097152
    v_mov_b32 v48, 0
    v_mov_b32 v49, 0
    v_mov_b32 v50, 0
    v_mov_b32 v51, 0
    v_mov_b32 v52, 0
    v_mov_b32 v53, 0
    v_mov_b32 v54, 0
    v_mov_b32 v55, 0
    s_mov_b32 exec_lo, 0xf
    s_mov_b32 exec_hi, 0xf
Lpoll_4:
    buffer_load_dwordx4 v[16:19], v12, s[64:67], s86 offen sc1
    s_add_u32 s76, s76, 1
    s_cmp_gt_u32 s76, 400000
    s_cbranch_scc1 L_end
    s_waitcnt vmcnt(0)
    v_cmp_ne_u64 vcc, s[72:73], v[18:19]
    s_cbranch_vccnz Lpoll_4
    s_mov_b64 exec, -1
    buffer_load_dwordx4 v[32:35], v9, s[64:67], s96 offen offset:0 sc1
    buffer_load_dwordx4 v[36:39], v9, s[64:67], s96 offen offset:2048 sc1
    buffer_load_dwordx4 v[40:43], v9, s[64:67], s92 offen offset:0 sc1
    buffer_load_dwordx4 v[44:47], v9, s[64:67], s92 offen offset:2048 sc1
    v_mov_b32 v20, v16
    s_nop 1
    v_max_f32_dpp v20, v20, v20 quad_perm:[1,0,3,2] row_mask:0xf bank_mask:0xf
    s_nop 1
    v_max_f32_dpp v20, v20, v20 quad_perm:[2,3,0,1] row_mask:0xf bank_mask:0xf
    v_mov_b32 v26, v20
    s_nop 1
    v_permlane32_swap_b32 v20, v26
    s_nop 0
    v_max_f32 v20, v20, v26
    v_sub_f32 v16, v16, v20
    v_exp_f32 v16, v16
    s_nop 0
    v_mul_f32 v21, v16, v17
    s_nop 1
    v_add_f32_dpp v21, v21, v21 quad_perm:[1,0,3,2] row_mask:0xf bank_mask:0xf
    s_nop 1
    v_add_f32_dpp v21, v21, v21 quad_perm:[2,3,0,1] row_mask:0xf bank_mask:0xf
    v_mov_b32 v26, v21
    s_nop 1
    v_permlane32_swap_b32 v21, v26
    s_nop 0
    v_add_f32 v21, v21, v26
    s_mov_b64 exec, 1
    ds_write_b64 v8, v[20:21]
    s_mov_b64 exec, -1
    v_mov_b32 v17, v16
    s_nop 1
    v_permlane16_swap_b32 v16, v17
    s_nop 1
    v_mov_b32_dpp v24, v16 row_newbcast:0 row_mask:0xf bank_mask:0xf
    v_mov_b32_dpp v26, v16 row_newbcast:1 row_mask:0xf bank_mask:0xf
    v_mov_b32_dpp v28, v16 row_newbcast:2 row_mask:0xf bank_mask:0xf
    v_mov_b32_dpp v30, v16 row_newbcast:3 row_mask:0xf bank_mask:0xf
    s_mov_b32 s94, 15
    s_waitcnt vmcnt(3)
    v_xor_b32 v32, v32, v252
    v_xor_b32 v33, v33, v253
    v_xor_b32 v34, v34, v254
    v_xor_b32 v35, v35, v255
    v_bitop3_b32 v64, v32, v33, s83 bitop3:0x80
    v_bitop3_b32 v64, v64, v34, v35 bitop3:0x80
    v_cmp_ne_u32 vcc, s83, v64
    v_lshlrev_b32 v56, 16, v32
    v_and_b32 v57, 0xffff0000, v32
    v_lshlrev_b32 v58, 16, v33
    v_and_b32 v59, 0xffff0000, v33
    v_lshlrev_b32 v60, 16, v34
    v_and_b32 v61, 0xffff0000, v34
    v_lshlrev_b32 v62, 16, v35
    v_and_b32 v63, 0xffff0000, v35
    s_cbranch_vccnz Ltk_5
    v_pk_fma_f32 v[48:49], v[56:57], v[24:25], v[48:49] op_sel_hi:[1,0,1]
    v_pk_fma_f32 v[50:51], v[58:59], v[24:25], v[50:51] op_sel_hi:[1,0,1]
    v_pk_fma_f32 v[52:53], v[60:61], v[24:25], v[52:53] op_sel_hi:[1,0,1]
    v_pk_fma_f32 v[54:55], v[62:63], v[24:25], v[54:55] op_sel_hi:[1,0,1]
    s_bitset0_b32 s94, 0
Ltk_5:
    s_waitcnt vmcnt(2)
    v_xor_b32 v36, v36, v252
    v_xor_b32 v37, v37, v253
    v_xor_b32 v38, v38, v254
    v_xor_b32 v39, v39, v255
    v_bitop3_b32 v64, v36, v37, s83 bitop3:0x80
    v_bitop3_b32 v64, v64, v38, v39 bitop3:0x80
    v_cmp_ne_u32 vcc, s83, v64
    v_lshlrev_b32 v56, 16, v36
    v_and_b32 v57, 0xffff0000, v36
    v_lshlrev_b32 v58, 16, v37
    v_and_b32 v59, 0xffff0000, v37
    v_lshlrev_b32 v60, 16, v38
    v_and_b32 v61, 0xffff0000, v38
    v_lshlrev_b32 v62, 16, v39
    v_and_b32 v63, 0xffff0000, v39
    s_cbranch_vccnz Ltk_6
    v_pk_fma_f32 v[48:49], v[56:57], v[26:27], v[48:49] op_sel_hi:[1,0,1]
    v_pk_fma_f32 v[50:51], v[58:59], v[26:27], v[50:51] op_sel_hi:[1,0,1]
    v_pk_fma_f32 v[52:53], v[60:61], v[26:27], v[52:53] op_sel_hi:[1,0,1]
    v_pk_fma_f32 v[54:55], v[62:63], v[26:27], v[54:55] op_sel_hi:[1,0,1]
    s_bitset0_b32 s94, 1
Ltk_6:
    s_waitcnt vmcnt(1)
    v_xor_b32 v40, v40, v252
    v_xor_b32 v41, v41, v253
    v_xor_b32 v42, v42, v254
    v_xor_b32 v43, v43, v255
    v_bitop3_b32 v64, v40, v41, s83 bitop3:0x80
    v_bitop3_b32 v64, v64, v42, v43 bitop3:0x80
    v_cmp_ne_u32 vcc, s83, v64
    v_lshlrev_b32 v56, 16, v40
    v_and_b32 v57, 0xffff0000, v40
    v_lshlrev_b32 v58, 16, v41
    v_and_b32 v59, 0xffff0000, v41
    v_lshlrev_b32 v60, 16, v42
    v_and_b32 v61, 0xffff0000, v42
    v_lshlrev_b32 v62, 16, v43
    v_and_b32 v63, 0xffff0000, v43
    s_cbranch_vccnz Ltk_7
    v_pk_fma_f32 v[48:49], v[56:57], v[28:29], v[48:49] op_sel_hi:[1,0,1]
    v_pk_fma_f32 v[50:51], v[58:59], v[28:29], v[50:51] op_sel_hi:[1,0,1]
    v_pk_fma_f32 v[52:53], v[60:61], v[28:29], v[52:53] op_sel_hi:[1,0,1]
    v_pk_fma_f32 v[54:55], v[62:63], v[28:29], v[54:55] op_sel_hi:[1,0,1]
    s_bitset0_b32 s94, 2
Ltk_7:
    s_waitcnt vmcnt(0)
    v_xor_b32 v44, v44, v252
    v_xor_b32 v45, v45, v253
    v_xor_b32 v46, v46, v254
    v_xor_b32 v47, v47, v255
    v_bitop3_b32 v64, v44, v45, s83 bitop3:0x80
    v_bitop3_b32 v64, v64, v46, v47 bitop3:0x80
    v_cmp_ne_u32 vcc, s83, v64
    v_lshlrev_b32 v56, 16, v44
    v_and_b32 v57, 0xffff0000, v44
    v_lshlrev_b32 v58, 16, v45
    v_and_b32 v59, 0xffff0000, v45
    v_lshlrev_b32 v60, 16, v46
    v_and_b32 v61, 0xffff0000, v46
    v_lshlrev_b32 v62, 16, v47
    v_and_b32 v63, 0xffff0000, v47
    s_cbranch_vccnz Ltk_8
    v_pk_fma_f32 v[48:49], v[56:57], v[30:31], v[48:49] op_sel_hi:[1,0,1]
    v_pk_fma_f32 v[50:51], v[58:59], v[30:31], v[50:51] op_sel_hi:[1,0,1]
    v_pk_fma_f32 v[52:53], v[60:61], v[30:31], v[52:53] op_sel_hi:[1,0,1]
    v_pk_fma_f32 v[54:55], v[62:63], v[30:31], v[54:55] op_sel_hi:[1,0,1]
    s_bitset0_b32 s94, 3
Ltk_8:
    s_cmp_eq_u32 s94, 0
    s_cbranch_scc1 L_bkx
L_bk0:
    s_bitcmp1_b32 s94, 0
    s_cbranch_scc0 Lrl_9
    buffer_load_dwordx4 v[32:35], v9, s[64:67], s96 offen offset:0 sc1
Lrl_9:
    s_bitcmp1_b32 s94, 1
    s_cbranch_scc0 Lrl_10
    buffer_load_dwordx4 v[36:39], v9, s[64:67], s96 offen offset:2048 sc1
Lrl_10:
    s_bitcmp1_b32 s94, 2
    s_cbranch_scc0 Lrl_11
    buffer_load_dwordx4 v[40:43], v9, s[64:67], s92 offen offset:0 sc1
Lrl_11:
    s_bitcmp1_b32 s94, 3
    s_cbranch_scc0 Lrl_12
    buffer_load_dwordx4 v[44:47], v9, s[64:67], s92 offen offset:2048 sc1
Lrl_12:
    s_add_u32 s76, s76, 0x10000
    s_cmp_gt_u32 s76, 0x7fff0000
    s_cbranch_scc1 L_end
    s_waitcnt vmcnt(0)
    s_bitcmp1_b32 s94, 0
    s_cbranch_scc0 Ltk_13
    v_xor_b32 v32, v32, v252
    v_xor_b32 v33, v33, v253
    v_xor_b32 v34, v34, v254
    v_xor_b32 v35, v35, v255
    v_bitop3_b32 v64, v32, v33, s83 bitop3:0x80
    v_bitop3_b32 v64, v64, v34, v35 bitop3:0x80
    v_cmp_ne_u32 vcc, s83, v64
    v_lshlrev_b32 v56, 16, v32
    v_and_b32 v57, 0xffff0000, v32
    v_lshlrev_b32 v58, 16, v33
    v_and_b32 v59, 0xffff0000, v33
    v_lshlrev_b32 v60, 16, v34
    v_and_b32 v61, 0xffff0000, v34
    v_lshlrev_b32 v62, 16, v35
    v_and_b32 v63, 0xffff0000, v35
    s_cbranch_vccnz Ltk_13
    v_pk_fma_f32 v[48:49], v[56:57], v[24:25], v[48:49] op_sel_hi:[1,0,1]
    v_pk_fma_f32 v[50:51], v[58:59], v[24:25], v[50:51] op_sel_hi:[1,0,1]
    v_pk_fma_f32 v[52:53], v[60:61], v[24:25], v[52:53] op_sel_hi:[1,0,1]
    v_pk_fma_f32 v[54:55], v[62:63], v[24:25], v[54:55] op_sel_hi:[1,0,1]
    s_bitset0_b32 s94, 0
Ltk_13:
    s_bitcmp1_b32 s94, 1
    s_cbranch_scc0 Ltk_14
    v_xor_b32 v36, v36, v252
    v_xor_b32 v37, v37, v253
    v_xor_b32 v38, v38, v254
    v_xor_b32 v39, v39, v255
    v_bitop3_b32 v64, v36, v37, s83 bitop3:0x80
    v_bitop3_b32 v64, v64, v38, v39 bitop3:0x80
    v_cmp_ne_u32 vcc, s83, v64
    v_lshlrev_b32 v56, 16, v36
    v_and_b32 v57, 0xffff0000, v36
    v_lshlrev_b32 v58, 16, v37
    v_and_b32 v59, 0xffff0000, v37
    v_lshlrev_b32 v60, 16, v38
    v_and_b32 v61, 0xffff0000, v38
    v_lshlrev_b32 v62, 16, v39
    v_and_b32 v63, 0xffff0000, v39
    s_cbranch_vccnz Ltk_14
    v_pk_fma_f32 v[48:49], v[56:57], v[26:27], v[48:49] op_sel_hi:[1,0,1]
    v_pk_fma_f32 v[50:51], v[58:59], v[26:27], v[50:51] op_sel_hi:[1,0,1]
    v_pk_fma_f32 v[52:53], v[60:61], v[26:27], v[52:53] op_sel_hi:[1,0,1]
    v_pk_fma_f32 v[54:55], v[62:63], v[26:27], v[54:55] op_sel_hi:[1,0,1]
    s_bitset0_b32 s94, 1
Ltk_14:
    s_bitcmp1_b32 s94, 2
    s_cbranch_scc0 Ltk_15
    v_xor_b32 v40, v40, v252
    v_xor_b32 v41, v41, v253
    v_xor_b32 v42, v42, v254
    v_xor_b32 v43, v43, v255
    v_bitop3_b32 v64, v40, v41, s83 bitop3:0x80
    v_bitop3_b32 v64, v64, v42, v43 bitop3:0x80
    v_cmp_ne_u32 vcc, s83, v64
    v_lshlrev_b32 v56, 16, v40
    v_and_b32 v57, 0xffff0000, v40
    v_lshlrev_b32 v58, 16, v41
    v_and_b32 v59, 0xffff0000, v41
    v_lshlrev_b32 v60, 16, v42
    v_and_b32 v61, 0xffff0000, v42
    v_lshlrev_b32 v62, 16, v43
    v_and_b32 v63, 0xffff0000, v43
    s_cbranch_vccnz Ltk_15
    v_pk_fma_f32 v[48:49], v[56:57], v[28:29], v[48:49] op_sel_hi:[1,0,1]
    v_pk_fma_f32 v[50:51], v[58:59], v[28:29], v[50:51] op_sel_hi:[1,0,1]
    v_pk_fma_f32 v[52:53], v[60:61], v[28:29], v[52:53] op_sel_hi:[1,0,1]
    v_pk_fma_f32 v[54:55], v[62:63], v[28:29], v[54:55] op_sel_hi:[1,0,1]
    s_bitset0_b32 s94, 2
Ltk_15:
    s_bitcmp1_b32 s94, 3
    s_cbranch_scc0 Ltk_16
    v_xor_b32 v44, v44, v252
    v_xor_b32 v45, v45, v253
    v_xor_b32 v46, v46, v254
    v_xor_b32 v47, v47, v255
    v_bitop3_b32 v64, v44, v45, s83 bitop3:0x80
    v_bitop3_b32 v64, v64, v46, v47 bitop3:0x80
    v_cmp_ne_u32 vcc, s83, v64
    v_lshlrev_b32 v56, 16, v44
    v_and_b32 v57, 0xffff0000, v44
    v_lshlrev_b32 v58, 16, v45
    v_and_b32 v59, 0xffff0000, v45
    v_lshlrev_b32 v60, 16, v46
    v_and_b32 v61, 0xffff0000, v46
    v_lshlrev_b32 v62, 16, v47
    v_and_b32 v63, 0xffff0000, v47
    s_cbranch_vccnz Ltk_16
    v_pk_fma_f32 v[48:49], v[56:57], v[30:31], v[48:49] op_sel_hi:[1,0,1]
    v_pk_fma_f32 v[50:51], v[58:59], v[30:31], v[50:51] op_sel_hi:[1,0,1]
    v_pk_fma_f32 v[52:53], v[60:61], v[30:31], v[52:53] op_sel_hi:[1,0,1]
    v_pk_fma_f32 v[54:55], v[62:63], v[30:31], v[54:55] op_sel_hi:[1,0,1]
    s_bitset0_b32 s94, 3
Ltk_16:
    s_cmp_eq_u32 s94, 0
    s_cbranch_scc0 L_bk0
L_bkx:
    s_lshr_b32 s97, s76, 16
    s_and_b32 s76, s76, 0xffff
    v_permlane32_swap_b32 v48, v52
    v_permlane32_swap_b32 v49, v53
    v_permlane32_swap_b32 v50, v54
    v_permlane32_swap_b32 v51, v55
    v_pk_add_f32 v[48:49], v[48:49], v[52:53]
    v_pk_add_f32 v[50:51], v[50:51], v[54:55]
    ds_write_b128 v11, v[48:51]
    s_cmp_lg_u32 s70, 1
    s_waitcnt lgkmcnt(0)
    s_barrier
    s_cbranch_scc1 L_cbd
    ds_read_b128 v[16:19], v66
    ds_read_b128 v[20:23], v66 offset:16
    ds_read_b128 v[32:35], v65 offset:0
    ds_read_b128 v[36:39], v65 offset:1024
    ds_read_b128 v[40:43], v65 offset:2048
    ds_read_b128 v[44:47], v65 offset:3072
    s_waitcnt lgkmcnt(4)
    v_max3_f32 v24, v16, v18, v20
    v_max_f32 v24, v24, v22
    v_sub_f32 v16, v16, v24
    v_sub_f32 v18, v18, v24
    v_sub_f32 v20, v20, v24
    v_sub_f32 v22, v22, v24
    v_exp_f32 v16, v16
    v_exp_f32 v18, v18
    v_exp_f32 v20, v20
    v_exp_f32 v22, v22
    v_mul_f32 v25, v16, v17
    v_fmac_f32 v25, v18, v19
    v_fmac_f32 v25, v20, v21
    v_fmac_f32 v25, v22, v23
    v_rcp_f32 v26, v25
    s_waitcnt lgkmcnt(0)
    v_pk_mul_f32 v[48:49], v[32:33], v[16:17] op_sel_hi:[1,0]
    v_pk_mul_f32 v[50:51], v[34:35], v[16:17] op_sel_hi:[1,0]
    v_pk_fma_f32 v[48:49], v[36:37], v[18:19], v[48:49] op_sel_hi:[1,0,1]
    v_pk_fma_f32 v[50:51], v[38:39], v[18:19], v[50:51] op_sel_hi:[1,0,1]
    v_pk_fma_f32 v[48:49], v[40:41], v[20:21], v[48:49] op_sel_hi:[1,0,1]
    v_pk_fma_f32 v[50:51], v[42:43], v[20:21], v[50:51] op_sel_hi:[1,0,1]
    v_pk_fma_f32 v[48:49], v[44:45], v[22:23], v[48:49] op_sel_hi:[1,0,1]
    v_pk_fma_f32 v[50:51], v[46:47], v[22:23], v[50:51] op_sel_hi:[1,0,1]
    v_pk_mul_f32 v[48:49], v[48:49], v[26:27] op_sel_hi:[1,0]
    v_pk_mul_f32 v[50:51], v[50:51], v[26:27] op_sel_hi:[1,0]
    v_cvt_pk_bf16_f32 v236, v48, v49
    v_cvt_pk_bf16_f32 v237, v50, v51
    s_cmp_eq_u32 s71, 0
    s_cbranch_scc1 Lsl_17
    buffer_store_dwordx4 v[236:239], v6, s[64:67], s93 offen
    s_branch Lsl_18
Lsl_17:
    buffer_store_dwordx4 v[236:239], v6, s[64:67], s93 offen sc1
Lsl_18:
L_cbd:
    s_cmp_lt_u32 s69, 16
    s_cbranch_scc1 L_F
Lpoll_19:
    buffer_load_dwordx4 v[208:211], v68, s[64:67], s80 offen sc1
    s_add_u32 s76, s76, 1
    s_cmp_gt_u32 s76, 400000
    s_cbranch_scc1 L_end
    s_waitcnt vmcnt(0)
    v_cmp_ne_u64 vcc, s[72:73], v[210:211]
    s_cbranch_vccnz Lpoll_19
    v_mfma_f32_16x16x16_bf16 v[144:147], v[208:209], v[80:81], 0
    v_mfma_f32_16x16x16_bf16 v[148:151], v[208:209], v[82:83], 0
    v_mfma_f32_16x16x16_bf16 v[152:155], v[208:209], v[84:85], 0
    v_mfma_f32_16x16x16_bf16 v[156:159], v[208:209], v[86:87], 0
    v_mfma_f32_16x16x16_bf16 v[160:163], v[208:209], v[88:89], 0
    v_mfma_f32_16x16x16_bf16 v[164:167], v[208:209], v[90:91], 0
    v_mfma_f32_16x16x16_bf16 v[168:171], v[208:209], v[92:93], 0
    v_mfma_f32_16x16x16_bf16 v[172:175], v[208:209], v[94:95], 0
    s_nop 1
    v_add_f32_dpp v216, v145, v144 row_shl:8 row_mask:0xf bank_mask:0xf
    v_add_f32_dpp v217, v149, v148 row_shl:8 row_mask:0xf bank_mask:0xf
    v_add_f32_dpp v218, v153, v152 row_shl:8 row_mask:0xf bank_mask:0xf
    v_add_f32_dpp v219, v157, v156 row_shl:8 row_mask:0xf bank_mask:0xf
    v_add_f32_dpp v220, v161, v160 row_shl:8 row_mask:0xf bank_mask:0xf
    v_add_f32_dpp v221, v165, v164 row_shl:8 row_mask:0xf bank_mask:0xf
    v_add_f32_dpp v222, v169, v168 row_shl:8 row_mask:0xf bank_mask:0xf
    v_add_f32_dpp v223, v173, v172 row_shl:8 row_mask:0xf bank_mask:0xf
    s_mov_b32 exec_lo, 0xff00ff
    s_mov_b32 exec_hi, 0xff00ff
    ds_write_b128 v70, v[216:219]
    ds_write_b128 v70, v[220:223] offset:16
    s_mov_b64 exec, -1
    s_waitcnt lgkmcnt(0)
    s_barrier
    s_cmp_lg_u32 s70, 7
    s_cbranch_scc1 L_clean
    ds_read_b128 v[144:147], v6 offset:0
    ds_read_b128 v[148:151], v6 offset:1024
    ds_read_b128 v[152:155], v6 offset:2048
    ds_read_b128 v[156:159], v6 offset:3072
    ds_read_b128 v[160:163], v6 offset:4096
    ds_read_b128 v[164:167], v6 offset:5120
    ds_read_b128 v[168:171], v6 offset:6144
    ds_read_b128 v[172:175], v6 offset:7168
    s_waitcnt lgkmcnt(6)
    v_pk_add_f32 v[144:145], v[144:145], v[148:149]
    v_pk_add_f32 v[146:147], v[146:147], v[150:151]
    s_waitcnt lgkmcnt(4)
    v_pk_add_f32 v[152:153], v[152:153], v[156:157]
    v_pk_add_f32 v[154:155], v[154:155], v[158:159]
    s_waitcnt lgkmcnt(2)
    v_pk_add_f32 v[160:161], v[160:161], v[164:165]
    v_pk_add_f32 v[162:163], v[162:163], v[166:167]
    s_waitcnt lgkmcnt(0)
    v_pk_add_f32 v[168:169], v[168:169], v[172:173]
    v_pk_add_f32 v[170:171], v[170:171], v[174:175]
    v_pk_add_f32 v[144:145], v[144:145], v[152:153]
    v_pk_add_f32 v[146:147], v[146:147], v[154:155]
    v_pk_add_f32 v[160:161], v[160:161], v[168:169]
    v_pk_add_f32 v[162:163], v[162:163], v[170:171]
    v_pk_add_f32 v[144:145], v[144:145], v[160:161]
    v_pk_add_f32 v[146:147], v[146:147], v[162:163]
    v_cvt_pk_bf16_f32 v236, v144, v145
    v_cvt_pk_bf16_f32 v237, v146, v147
    s_cmp_eq_u32 s71, 0
    s_cbranch_scc1 Lsl_20
    buffer_store_dwordx4 v[236:239], v71, s[64:67], s81 offen
    s_branch Lsl_21
Lsl_20:
    buffer_store_dwordx4 v[236:239], v71, s[64:67], s81 offen sc1
Lsl_21:
    s_branch L_fin
L_clean:
    s_mov_b32 s94, s100
    s_mov_b32 s97, s101
    s_cmp_eq_u32 s69, 31
    s_cbranch_scc1 L_F1
    s_cmp_lt_u32 s70, 2
    s_cbranch_scc0 L_fin
L_red:
    s_cmp_lt_u32 s69, 26
    s_cbranch_scc0 L_fin
    s_and_b32 s94, s69, 15
    v_and_b32 v12, 1, v1
    v_mul_u32_u24 v13, 1280, v12
    v_lshl_add_u32 v13, v2, 3, v13
    v_lshrrev_b32 v15, 5, v0
    v_lshl_add_u32 v13, v15, 2, v13
    s_mul_i32 s90, s70, 2560
    s_lshl_b32 s93, s94, 7
    s_add_u32 s90, s90, s93
    buffer_load_dword v200, v13, s[28:31], s90 offen
    v_mul_u32_u24 v13, 2560, v12
    v_lshl_add_u32 v13, v2, 4, v13
    s_mul_i32 s96, s68, 10240
    s_mul_i32 s90, s70, 5120
    s_add_u32 s96, s96, s90
    s_lshl_b32 s90, s94, 8
    s_add_u32 s96, s96, s90
    s_add_u32 s96, s96, 1703936
    v_and_b32 v14, 0x1ff, v6
    v_lshl_add_u32 v14, v15, 10, v14
    s_lshl_b32 s95, s94, 13
    s_lshl_b32 s90, s70, 9
    s_add_u32 s95, s95, s90
    s_add_u32 s95, s95, 1572864
    s_add_u32 s93, s95, 4096
Lpoll_22:
    buffer_load_dwordx4 v[144:147], v14, s[64:67], s95 offen offset:0 sc1
    buffer_load_dwordx4 v[148:151], v14, s[64:67], s95 offen offset:2048 sc1
    buffer_load_dwordx4 v[152:155], v14, s[64:67], s93 offen offset:0 sc1
    buffer_load_dwordx4 v[156:159], v14, s[64:67], s93 offen offset:2048 sc1
    s_add_u32 s76, s76, 1
    s_cmp_gt_u32 s76, 400000
    s_cbranch_scc1 L_end
    s_waitcnt vmcnt(0)
    v_cmp_ne_u64 vcc, s[72:73], v[146:147]
    v_cmp_ne_u64 s[98:99], s[72:73], v[150:151]
    s_or_b64 vcc, vcc, s[98:99]
    v_cmp_ne_u64 s[98:99], s[72:73], v[154:155]
    s_or_b64 vcc, vcc, s[98:99]
    v_cmp_ne_u64 s[98:99], s[72:73], v[158:159]
    s_or_b64 vcc, vcc, s[98:99]
    s_cbranch_vccnz Lpoll_22
    v_lshlrev_b32 v160, 16, v144
    v_and_b32 v161, 0xffff0000, v144
    v_lshlrev_b32 v162, 16, v145
    v_and_b32 v163, 0xffff0000, v145
    v_lshlrev_b32 v164, 16, v148
    v_and_b32 v165, 0xffff0000, v148
    v_lshlrev_b32 v166, 16, v149
    v_and_b32 v167, 0xffff0000, v149
    v_lshlrev_b32 v168, 16, v152
    v_and_b32 v169, 0xffff0000, v152
    v_lshlrev_b32 v170, 16, v153
    v_and_b32 v171, 0xffff0000, v153
    v_lshlrev_b32 v172, 16, v156
    v_and_b32 v173, 0xffff0000, v156
    v_lshlrev_b32 v174, 16, v157
    v_and_b32 v175, 0xffff0000, v157
    v_lshlrev_b32 v202, 16, v200
    v_and_b32 v203, 0xffff0000, v200
    v_pk_add_f32 v[160:161], v[160:161], v[164:165]
    v_pk_add_f32 v[162:163], v[162:163], v[166:167]
    v_pk_add_f32 v[168:169], v[168:169], v[172:173]
    v_pk_add_f32 v[170:171], v[170:171], v[174:175]
    v_pk_add_f32 v[160:161], v[160:161], v[168:169]
    v_pk_add_f32 v[162:163], v[162:163], v[170:171]
    s_nop 1
    v_permlane32_swap_b32 v160, v162
    v_permlane32_swap_b32 v161, v163
    s_nop 0
    v_pk_add_f32 v[160:161], v[160:161], v[162:163]
    v_pk_add_f32 v[160:161], v[160:161], v[202:203]
    v_cvt_pk_bf16_f32 v236, v160, v161
    v_cvt_pk_bf16_f32 v237, v160, v161
    s_nop 1
    v_permlane32_swap_b32 v236, v237
    s_mov_b32 exec_lo, 0xffffffff
    s_mov_b32 exec_hi, 0x0
    s_cmp_eq_u32 s71, 0
    s_cbranch_scc1 Lsl_23
    buffer_store_dwordx4 v[236:239], v13, s[64:67], s96 offen
    s_branch Lsl_24
Lsl_23:
    buffer_store_dwordx4 v[236:239], v13, s[64:67], s96 offen sc1
Lsl_24:
    s_mov_b64 exec, -1
    s_branch L_fin
L_s8:
    s_lshl_b32 s94, s2, 1
    s_and_b32 s90, s70, 1
    s_add_u32 s94, s94, s90
    s_mul_i32 s90, s94, 1639
    s_lshr_b32 s90, s90, 16
    s_mul_i32 s93, s90, 40
    s_sub_u32 s93, s94, s93
    s_lshr_b32 s95, s93, 3
    s_lshl_b32 s95, s95, 5
    s_bfe_u32 s96, s93, 0x10002
    s_add_u32 s95, s95, s96
    s_and_b32 s96, s93, 3
    s_lshl_b32 s96, s96, 3
    s_add_u32 s95, s95, s96
    v_mul_u32_u24 v12, 10240, v5
    v_lshl_add_u32 v12, v4, 4, v12
    s_lshl_b32 s78, s94, 6
    s_add_u32 s78, s78, 2621440
    s_add_u32 s79, s78, 163840
    s_add_u32 s80, s78, 327680
    s_add_u32 s81, s78, 491520
    v_add_u32 v13, s81, v12
    s_lshl_b32 s82, s68, 2
    s_add_u32 s82, s82, s90
    s_mul_i32 s82, s82, 160
    s_add_u32 s82, s82, s95
    s_lshl_b32 s82, s82, 4
    s_add_u32 s82, s82, 1703936
    v_lshlrev_b32 v14, 5, v4
    v_add_u32 v14, s82, v14
    v_cmp_gt_u32 vcc, 6, v5
    s_nop 1
    v_cndmask_b32 v13, v14, v13, vcc
    s_mul_i32 s83, s90, 1280
    s_lshl_b32 s84, s95, 3
    s_add_u32 s83, s83, s84
    v_lshlrev_b32 v15, 4, v4
    v_lshl_add_u32 v15, v1, 1, v15
    s_sleep 4
    buffer_load_dwordx4 v[144:147], v12, s[64:67], s78 offen sc1
    buffer_load_dwordx4 v[148:151], v12, s[64:67], s79 offen sc1
    buffer_load_dwordx4 v[152:155], v12, s[64:67], s80 offen sc1
    buffer_load_dwordx4 v[156:159], v13, s[64:67], 0 offen sc1
    s_branch Lpf_26
Lpoll_25:
    s_sleep 2
Lpf_26:
    buffer_load_dwordx4 v[164:167], v14, s[64:67], 0 offen sc1
    s_add_u32 s76, s76, 1
    s_cmp_gt_u32 s76, 400000
    s_cbranch_scc1 L_end
    s_waitcnt vmcnt(0)
    v_cmp_ne_u64 vcc, s[72:73], v[166:167]
    s_cbranch_vccnz Lpoll_25
Lpoll_27:
    buffer_load_dwordx4 v[144:147], v12, s[64:67], s78 offen sc1
    buffer_load_dwordx4 v[148:151], v12, s[64:67], s79 offen sc1
    buffer_load_dwordx4 v[152:155], v12, s[64:67], s80 offen sc1
    buffer_load_dwordx4 v[156:159], v13, s[64:67], 0 offen sc1
    s_add_u32 s76, s76, 1
    s_cmp_gt_u32 s76, 400000
    s_cbranch_scc1 L_end
    s_waitcnt vmcnt(0)
    v_cmp_ne_u64 vcc, s[72:73], v[146:147]
    v_cmp_ne_u64 s[98:99], s[72:73], v[150:151]
    s_or_b64 vcc, vcc, s[98:99]
    v_cmp_ne_u64 s[98:99], s[72:73], v[154:155]
    s_or_b64 vcc, vcc, s[98:99]
    v_cmp_ne_u64 s[98:99], s[72:73], v[158:159]
    s_or_b64 vcc, vcc, s[98:99]
    s_cbranch_vccnz Lpoll_27
    v_cmp_gt_u32 vcc, 7, v5
    s_nop 1
    v_cndmask_b32 v156, 0, v156, vcc
    v_cndmask_b32 v157, 0, v157, vcc
    v_lshlrev_b32 v160, 16, v144
    v_and_b32 v161, 0xffff0000, v144
    v_lshlrev_b32 v162, 16, v145
    v_and_b32 v163, 0xffff0000, v145
    v_lshlrev_b32 v164, 16, v148
    v_and_b32 v165, 0xffff0000, v148
    v_lshlrev_b32 v166, 16, v149
    v_and_b32 v167, 0xffff0000, v149
    v_lshlrev_b32 v168, 16, v152
    v_and_b32 v169, 0xffff0000, v152
    v_lshlrev_b32 v170, 16, v153
    v_and_b32 v171, 0xffff0000, v153
    v_lshlrev_b32 v172, 16, v156
    v_and_b32 v173, 0xffff0000, v156
    v_lshlrev_b32 v174, 16, v157
    v_and_b32 v175, 0xffff0000, v157
    v_pk_add_f32 v[160:161], v[160:161], v[164:165]
    v_pk_add_f32 v[162:163], v[162:163], v[166:167]
    v_pk_add_f32 v[168:169], v[168:169], v[172:173]
    v_pk_add_f32 v[170:171], v[170:171], v[174:175]
    v_pk_add_f32 v[160:161], v[160:161], v[168:169]
    v_pk_add_f32 v[162:163], v[162:163], v[170:171]
    s_nop 1
    v_permlane32_swap_b32 v160, v162
    v_permlane32_swap_b32 v161, v163
    s_nop 0
    v_pk_add_f32 v[160:161], v[160:161], v[162:163]
    s_nop 1
    v_permlane16_swap_b32 v160, v161
    s_nop 0
    v_add_f32 v160, v160, v161
    s_nop 1
    v_add_f32_dpp v160, v160, v160 row_ror:8 row_mask:0xf bank_mask:0xf
    s_nop 1
    v_add_f32_dpp v160, v160, v160 row_ror:4 row_mask:0xf bank_mask:0xf
    s_nop 0
    v_cvt_pk_bf16_f32 v160, v160, v160
    s_mov_b32 exec_lo, 0xf000f
    s_mov_b32 exec_hi, 0xf000f
    buffer_store_short v160, v15, s[60:63], s83 offen
    s_mov_b64 exec, -1
    s_cmp_lg_u32 s94, 0
    s_cbranch_scc1 L_s8x
    v_mov_b32 v12, 0
    s_mov_b64 exec, 1
    buffer_store_dwordx2 v[238:239], v12, s[64:67], 0 offen sc1
    s_mov_b64 exec, -1
L_s8x:
    s_branch L_fin
L_F:
    s_barrier
    s_waitcnt vmcnt(4)
    s_cmp_lt_u32 s70, 4
    s_cbranch_scc0 L_f2xl
    s_cmp_lt_u32 s69, 16
    s_cbranch_scc0 L_f2xl
    s_add_u32 s90, s91, 5120
    s_cmp_lt_u32 s69, 10
    s_cbranch_scc0 L_f2bl
    buffer_load_dwordx4 v[192:195], v244, s[48:51], s90 offen offset:0 nt
    buffer_load_dwordx4 v[196:199], v244, s[48:51], s90 offen offset:1280 nt
    buffer_load_dwordx4 v[200:203], v244, s[48:51], s90 offen offset:2560 nt
    buffer_load_dwordx4 v[204:207], v244, s[48:51], s90 offen offset:3840 nt
    s_branch L_f2xl
L_f2bl:
    buffer_load_dwordx4 v[192:195], v247, s[56:59], s90 offen offset:0 nt
    buffer_load_dwordx4 v[196:199], v247, s[56:59], s90 offen offset:1280 nt
    buffer_load_dwordx4 v[200:203], v247, s[56:59], s90 offen offset:2560 nt
    buffer_load_dwordx4 v[204:207], v247, s[56:59], s90 offen offset:3840 nt
L_f2xl:
    s_mov_b32 s94, s100
    s_mov_b32 s97, s101
    s_cmp_lt_u32 s69, 10
    s_cbranch_scc0 L_F1
    s_lshl_b32 s90, s69, 3
    s_add_u32 s90, s90, s70
    s_mul_i32 s92, s68, 7
    s_add_u32 s92, s92, 6
    s_cmp_lt_u32 s90, 40
    s_cbranch_scc0 L_hp2
    s_lshl_b32 s92, s92, 6
    v_mul_u32_u24 v15, 3456, v5
    v_lshl_add_u32 v15, v4, 4, v15
    s_mul_i32 s90, s90, 55296
    s_add_u32 s90, s90, s92
    buffer_load_dwordx4 v[48:51], v15, s[52:55], s90 offen
    s_branch L_s5
L_hp2:
    s_sub_u32 s90, s90, 40
    s_lshl_b32 s90, s90, 10
    s_mul_i32 s92, s92, 40960
    s_add_u32 s90, s90, s92
    buffer_load_dwordx4 v[48:51], v6, s[56:59], s90 offen
L_s5:
    s_waitcnt vmcnt(1)
    v_perm_b32 v112, v216, v212, s74
    v_perm_b32 v113, v224, v220, s74
    v_perm_b32 v114, v196, v192, s74
    v_perm_b32 v115, v204, v200, s74
    v_perm_b32 v116, v216, v212, s75
    v_perm_b32 v117, v224, v220, s75
    v_perm_b32 v118, v196, v192, s75
    v_perm_b32 v119, v204, v200, s75
    v_perm_b32 v120, v217, v213, s74
    v_perm_b32 v121, v225, v221, s74
    v_perm_b32 v122, v197, v193, s74
    v_perm_b32 v123, v205, v201, s74
    v_perm_b32 v124, v217, v213, s75
    v_perm_b32 v125, v225, v221, s75
    v_perm_b32 v126, v197, v193, s75
    v_perm_b32 v127, v205, v201, s75
    v_perm_b32 v128, v218, v214, s74
    v_perm_b32 v129, v226, v222, s74
    v_perm_b32 v130, v198, v194, s74
    v_perm_b32 v131, v206, v202, s74
    v_perm_b32 v132, v218, v214, s75
    v_perm_b32 v133, v226, v222, s75
    v_perm_b32 v134, v198, v194, s75
    v_perm_b32 v135, v206, v202, s75
    v_perm_b32 v136, v219, v215, s74
    v_perm_b32 v137, v227, v223, s74
    v_perm_b32 v138, v199, v195, s74
    v_perm_b32 v139, v207, v203, s74
    v_perm_b32 v140, v219, v215, s75
    v_perm_b32 v141, v227, v223, s75
    v_perm_b32 v142, v199, v195, s75
    v_perm_b32 v143, v207, v203, s75
    v_lshl_add_u32 v12, v3, 11, v7
    s_lshl_b32 s95, s68, 14
    s_lshl_b32 s90, s70, 8
    s_add_u32 s95, s95, s90
    s_add_u32 s95, s95, 1441792
    s_add_u32 s96, s95, 8192
    v_and_b32 v14, 7, v0
    v_lshlrev_b32 v14, 5, v14
    v_lshl_add_u32 v14, v1, 8, v14
    s_lshl_b32 s90, s70, 10
    s_add_u32 s90, s90, 0
    v_add_u32 v14, s90, v14
Lpoll_28:
    buffer_load_dwordx4 v[208:211], v12, s[64:67], s95 offen sc1
    buffer_load_dwordx4 v[212:215], v12, s[64:67], s96 offen sc1
    s_add_u32 s76, s76, 1
    s_cmp_gt_u32 s76, 400000
    s_cbranch_scc1 L_end
    s_waitcnt vmcnt(0)
    v_cmp_ne_u64 vcc, s[72:73], v[210:211]
    v_cmp_ne_u64 s[98:99], s[72:73], v[214:215]
    s_or_b64 vcc, vcc, s[98:99]
    s_cbranch_vccnz Lpoll_28
    v_lshlrev_b32 v216, 16, v208
    v_and_b32 v217, 0xffff0000, v208
    v_lshlrev_b32 v218, 16, v209
    v_and_b32 v219, 0xffff0000, v209
    v_lshlrev_b32 v220, 16, v212
    v_and_b32 v221, 0xffff0000, v212
    v_lshlrev_b32 v222, 16, v213
    v_and_b32 v223, 0xffff0000, v213
    v_pk_add_f32 v[216:217], v[216:217], v[220:221]
    v_pk_add_f32 v[218:219], v[218:219], v[222:223]
    v_cvt_pk_bf16_f32 v208, v216, v217
    v_cvt_pk_bf16_f32 v209, v218, v219
    s_nop 1
    v_mov_b32_dpp v212, v208 quad_perm:[0,2,0,2] row_mask:0xf bank_mask:0xf
    v_mov_b32_dpp v213, v209 quad_perm:[0,2,0,2] row_mask:0xf bank_mask:0xf
    v_mov_b32_dpp v214, v208 quad_perm:[1,3,1,3] row_mask:0xf bank_mask:0xf
    v_mov_b32_dpp v215, v209 quad_perm:[1,3,1,3] row_mask:0xf bank_mask:0xf
    s_nop 1
    v_mfma_f32_16x16x32_bf16 v[144:147], v[212:215], v[112:115], 0
    v_mfma_f32_16x16x32_bf16 v[148:151], v[212:215], v[116:119], 0
    v_mfma_f32_16x16x32_bf16 v[152:155], v[212:215], v[120:123], 0
    v_mfma_f32_16x16x32_bf16 v[156:159], v[212:215], v[124:127], 0
    v_mfma_f32_16x16x32_bf16 v[160:163], v[212:215], v[128:131], 0
    v_mfma_f32_16x16x32_bf16 v[164:167], v[212:215], v[132:135], 0
    v_mfma_f32_16x16x32_bf16 v[168:171], v[212:215], v[136:139], 0
    v_mfma_f32_16x16x32_bf16 v[172:175], v[212:215], v[140:143], 0
    s_nop 1
    v_add_f32_dpp v216, v145, v144 row_shl:8 row_mask:0xf bank_mask:0xf
    v_add_f32_dpp v217, v149, v148 row_shl:8 row_mask:0xf bank_mask:0xf
    v_add_f32_dpp v218, v153, v152 row_shl:8 row_mask:0xf bank_mask:0xf
    v_add_f32_dpp v219, v157, v156 row_shl:8 row_mask:0xf bank_mask:0xf
    v_add_f32_dpp v220, v161, v160 row_shl:8 row_mask:0xf bank_mask:0xf
    v_add_f32_dpp v221, v165, v164 row_shl:8 row_mask:0xf bank_mask:0xf
    v_add_f32_dpp v222, v169, v168 row_shl:8 row_mask:0xf bank_mask:0xf
    v_add_f32_dpp v223, v173, v172 row_shl:8 row_mask:0xf bank_mask:0xf
    s_mov_b32 exec_lo, 0xff00ff
    s_mov_b32 exec_hi, 0xff00ff
    ds_write_b128 v14, v[216:219]
    ds_write_b128 v14, v[220:223] offset:16
    s_mov_b64 exec, -1
    s_waitcnt lgkmcnt(0)
    s_barrier
    s_and_b32 s90, s70, 6
    s_cmp_eq_u32 s90, 2
    s_cbranch_scc1 L_s8
    s_cmp_lg_u32 s70, 7
    s_cbranch_scc1 L_fin
    ds_read_b128 v[144:147], v6 offset:0
    ds_read_b128 v[148:151], v6 offset:1024
    ds_read_b128 v[152:155], v6 offset:2048
    ds_read_b128 v[156:159], v6 offset:3072
    ds_read_b128 v[160:163], v6 offset:4096
    ds_read_b128 v[164:167], v6 offset:5120
    ds_read_b128 v[168:171], v6 offset:6144
    ds_read_b128 v[172:175], v6 offset:7168
    s_lshl_b32 s95, s69, 3
    s_add_u32 s95, s95, s68
    s_lshl_b32 s95, s95, 10
    s_add_u32 s95, s95, 1572864
    s_waitcnt lgkmcnt(6)
    v_pk_add_f32 v[144:145], v[144:145], v[148:149]
    v_pk_add_f32 v[146:147], v[146:147], v[150:151]
    s_waitcnt lgkmcnt(4)
    v_pk_add_f32 v[152:153], v[152:153], v[156:157]
    v_pk_add_f32 v[154:155], v[154:155], v[158:159]
    s_waitcnt lgkmcnt(2)
    v_pk_add_f32 v[160:161], v[160:161], v[164:165]
    v_pk_add_f32 v[162:163], v[162:163], v[166:167]
    s_waitcnt lgkmcnt(0)
    v_pk_add_f32 v[168:169], v[168:169], v[172:173]
    v_pk_add_f32 v[170:171], v[170:171], v[174:175]
    v_pk_add_f32 v[144:145], v[144:145], v[152:153]
    v_pk_add_f32 v[146:147], v[146:147], v[154:155]
    v_pk_add_f32 v[160:161], v[160:161], v[168:169]
    v_pk_add_f32 v[162:163], v[162:163], v[170:171]
    v_pk_add_f32 v[144:145], v[144:145], v[160:161]
    v_pk_add_f32 v[146:147], v[146:147], v[162:163]
    v_cvt_pk_bf16_f32 v236, v144, v145
    v_cvt_pk_bf16_f32 v237, v146, v147
    buffer_store_dwordx4 v[236:239], v6, s[64:67], s95 offen sc1
    s_branch L_fin
L_F1:
    s_cmp_lt_u32 s97, 54
    s_cbranch_scc0 L_fin
    s_cmp_lt_u32 s69, 16
    s_cbranch_scc1 L_F1a
    s_sleep 4
    s_mul_i32 s91, s94, 40960
    s_lshl_b32 s90, s70, 8
    s_add_u32 s91, s91, s90
    s_add_u32 s90, s91, 5120
    buffer_load_dwordx4 v[212:215], v247, s[56:59], s91 offen offset:0 nt
    buffer_load_dwordx4 v[216:219], v247, s[56:59], s91 offen offset:1280 nt
    buffer_load_dwordx4 v[220:223], v247, s[56:59], s91 offen offset:2560 nt
    buffer_load_dwordx4 v[224:227], v247, s[56:59], s91 offen offset:3840 nt
    buffer_load_dwordx4 v[192:195], v247, s[56:59], s90 offen offset:0 nt
    buffer_load_dwordx4 v[196:199], v247, s[56:59], s90 offen offset:1280 nt
    buffer_load_dwordx4 v[200:203], v247, s[56:59], s90 offen offset:2560 nt
    buffer_load_dwordx4 v[204:207], v247, s[56:59], s90 offen offset:3840 nt
L_F1a:
    v_mul_u32_u24 v15, 13824, v5
    v_lshl_add_u32 v15, v4, 4, v15
    s_mul_i32 s93, s70, 442368
    s_lshl_b32 s90, s94, 6
    s_add_u32 s93, s93, s90
    s_add_u32 s90, s93, 0
    buffer_load_dwordx4 v[16:19], v15, s[52:55], s90 offen
    s_add_u32 s90, s93, 3456
    buffer_load_dwordx4 v[20:23], v15, s[52:55], s90 offen
    s_add_u32 s90, s93, 6912
    buffer_load_dwordx4 v[24:27], v15, s[52:55], s90 offen
    s_add_u32 s90, s93, 10368
    buffer_load_dwordx4 v[28:31], v15, s[52:55], s90 offen
    s_add_u32 s90, s93, 221184
    buffer_load_dwordx4 v[32:35], v15, s[52:55], s90 offen
    s_add_u32 s90, s93, 224640
    buffer_load_dwordx4 v[36:39], v15, s[52:55], s90 offen
    s_add_u32 s90, s93, 228096
    buffer_load_dwordx4 v[40:43], v15, s[52:55], s90 offen
    s_add_u32 s90, s93, 231552
    buffer_load_dwordx4 v[44:47], v15, s[52:55], s90 offen
    s_waitcnt vmcnt(8)
    v_perm_b32 v112, v216, v212, s74
    v_perm_b32 v113, v224, v220, s74
    v_perm_b32 v114, v196, v192, s74
    v_perm_b32 v115, v204, v200, s74
    v_perm_b32 v116, v216, v212, s75
    v_perm_b32 v117, v224, v220, s75
    v_perm_b32 v118, v196, v192, s75
    v_perm_b32 v119, v204, v200, s75
    v_perm_b32 v120, v217, v213, s74
    v_perm_b32 v121, v225, v221, s74
    v_perm_b32 v122, v197, v193, s74
    v_perm_b32 v123, v205, v201, s74
    v_perm_b32 v124, v217, v213, s75
    v_perm_b32 v125, v225, v221, s75
    v_perm_b32 v126, v197, v193, s75
    v_perm_b32 v127, v205, v201, s75
    v_perm_b32 v128, v218, v214, s74
    v_perm_b32 v129, v226, v222, s74
    v_perm_b32 v130, v198, v194, s74
    v_perm_b32 v131, v206, v202, s74
    v_perm_b32 v132, v218, v214, s75
    v_perm_b32 v133, v226, v222, s75
    v_perm_b32 v134, v198, v194, s75
    v_perm_b32 v135, v206, v202, s75
    v_perm_b32 v136, v219, v215, s74
    v_perm_b32 v137, v227, v223, s74
    v_perm_b32 v138, v199, v195, s74
    v_perm_b32 v139, v207, v203, s74
    v_perm_b32 v140, v219, v215, s75
    v_perm_b32 v141, v227, v223, s75
    v_perm_b32 v142, v199, v195, s75
    v_perm_b32 v143, v207, v203, s75
    s_waitcnt vmcnt(0)
    v_perm_b32 v80, v20, v16, s74
    v_perm_b32 v81, v28, v24, s74
    v_perm_b32 v82, v36, v32, s74
    v_perm_b32 v83, v44, v40, s74
    v_perm_b32 v84, v20, v16, s75
    v_perm_b32 v85, v28, v24, s75
    v_perm_b32 v86, v36, v32, s75
    v_perm_b32 v87, v44, v40, s75
    v_perm_b32 v88, v21, v17, s74
    v_perm_b32 v89, v29, v25, s74
    v_perm_b32 v90, v37, v33, s74
    v_perm_b32 v91, v45, v41, s74
    v_perm_b32 v92, v21, v17, s75
    v_perm_b32 v93, v29, v25, s75
    v_perm_b32 v94, v37, v33, s75
    v_perm_b32 v95, v45, v41, s75
    v_perm_b32 v96, v22, v18, s74
    v_perm_b32 v97, v30, v26, s74
    v_perm_b32 v98, v38, v34, s74
    v_perm_b32 v99, v46, v42, s74
    v_perm_b32 v100, v22, v18, s75
    v_perm_b32 v101, v30, v26, s75
    v_perm_b32 v102, v38, v34, s75
    v_perm_b32 v103, v46, v42, s75
    v_perm_b32 v104, v23, v19, s74
    v_perm_b32 v105, v31, v27, s74
    v_perm_b32 v106, v39, v35, s74
    v_perm_b32 v107, v47, v43, s74
    v_perm_b32 v108, v23, v19, s75
    v_perm_b32 v109, v31, v27, s75
    v_perm_b32 v110, v39, v35, s75
    v_perm_b32 v111, v47, v43, s75
    v_mov_b32 v48, 0x3f803f80
    v_mov_b32 v49, 0x3f803f80
    v_mov_b32 v50, 0x3f803f80
    v_mov_b32 v51, 0x3f803f80
    s_nop 1
    v_mfma_f32_16x16x32_bf16 v[16:19], v[48:51], v[80:83], 0
    v_mfma_f32_16x16x32_bf16 v[20:23], v[48:51], v[84:87], 0
    v_mfma_f32_16x16x32_bf16 v[24:27], v[48:51], v[88:91], 0
    v_mfma_f32_16x16x32_bf16 v[28:31], v[48:51], v[92:95], 0
    v_mfma_f32_16x16x32_bf16 v[32:35], v[48:51], v[96:99], 0
    v_mfma_f32_16x16x32_bf16 v[36:39], v[48:51], v[100:103], 0
    v_mfma_f32_16x16x32_bf16 v[40:43], v[48:51], v[104:107], 0
    v_mfma_f32_16x16x32_bf16 v[44:47], v[48:51], v[108:111], 0
    s_nop 1
    v_add_f32_dpp v56, v17, v16 row_shl:4 row_mask:0xf bank_mask:0xf
    v_add_f32_dpp v57, v21, v20 row_shl:4 row_mask:0xf bank_mask:0xf
    v_add_f32_dpp v58, v25, v24 row_shl:4 row_mask:0xf bank_mask:0xf
    v_add_f32_dpp v59, v29, v28 row_shl:4 row_mask:0xf bank_mask:0xf
    v_add_f32_dpp v60, v33, v32 row_shl:4 row_mask:0xf bank_mask:0xf
    v_add_f32_dpp v61, v37, v36 row_shl:4 row_mask:0xf bank_mask:0xf
    v_add_f32_dpp v62, v41, v40 row_shl:4 row_mask:0xf bank_mask:0xf
    v_add_f32_dpp v63, v45, v44 row_shl:4 row_mask:0xf bank_mask:0xf
    v_add_f32_dpp v56, v18, v56 row_shl:8 row_mask:0xf bank_mask:0xf
    v_add_f32_dpp v57, v22, v57 row_shl:8 row_mask:0xf bank_mask:0xf
    v_add_f32_dpp v58, v26, v58 row_shl:8 row_mask:0xf bank_mask:0xf
    v_add_f32_dpp v59, v30, v59 row_shl:8 row_mask:0xf bank_mask:0xf
    v_add_f32_dpp v60, v34, v60 row_shl:8 row_mask:0xf bank_mask:0xf
    v_add_f32_dpp v61, v38, v61 row_shl:8 row_mask:0xf bank_mask:0xf
    v_add_f32_dpp v62, v42, v62 row_shl:8 row_mask:0xf bank_mask:0xf
    v_add_f32_dpp v63, v46, v63 row_shl:8 row_mask:0xf bank_mask:0xf
    v_add_f32_dpp v56, v19, v56 row_shl:12 row_mask:0xf bank_mask:0xf
    v_add_f32_dpp v57, v23, v57 row_shl:12 row_mask:0xf bank_mask:0xf
    v_add_f32_dpp v58, v27, v58 row_shl:12 row_mask:0xf bank_mask:0xf
    v_add_f32_dpp v59, v31, v59 row_shl:12 row_mask:0xf bank_mask:0xf
    v_add_f32_dpp v60, v35, v60 row_shl:12 row_mask:0xf bank_mask:0xf
    v_add_f32_dpp v61, v39, v61 row_shl:12 row_mask:0xf bank_mask:0xf
    v_add_f32_dpp v62, v43, v62 row_shl:12 row_mask:0xf bank_mask:0xf
    v_add_f32_dpp v63, v47, v63 row_shl:12 row_mask:0xf bank_mask:0xf
    v_lshlrev_b32 v14, 5, v4
    s_lshl_b32 s90, s70, 7
    s_add_u32 s90, s90, 33792
    v_add_u32 v14, s90, v14
    s_mov_b64 exec, 15
    ds_write_b128 v14, v[56:59]
    ds_write_b128 v14, v[60:63] offset:16
    s_mov_b64 exec, -1
    s_waitcnt lgkmcnt(0)
    s_barrier
L_s67:
    v_lshrrev_b32 v14, 1, v7
    ds_read_b64 v[16:17], v14 offset:33792
    ds_read_b64 v[18:19], v14 offset:33920
    ds_read_b64 v[20:21], v14 offset:34048
    ds_read_b64 v[22:23], v14 offset:34176
    ds_read_b64 v[24:25], v14 offset:34304
    v_mul_u32_u24 v12, 2560, v3
    v_add_u32 v12, v12, v7
    s_mul_i32 s95, s68, 10240
    s_lshl_b32 s90, s70, 9
    s_add_u32 s95, s95, s90
    s_add_u32 s95, s95, 1703936
    v_lshlrev_b32 v13, 1, v7
    s_add_u32 s90, s90, 16384
    v_add_u32 v13, s90, v13
    v_lshlrev_b32 v10, 3, v1
    s_lshl_b32 s90, s70, 5
    s_add_u32 s90, s90, 32768
    v_add_u32 v10, s90, v10
    v_lshl_add_u32 v14, v3, 7, v14
    v_lshlrev_b32 v11, 3, v3
    v_mul_u32_u24 v9, 2560, v1
    v_lshl_add_u32 v9, v2, 4, v9
    s_mul_i32 s96, s94, 10240
    s_lshl_b32 s90, s70, 9
    s_add_u32 s96, s96, s90
    s_add_u32 s96, s96, 2621440
    s_waitcnt lgkmcnt(0)
    v_pk_add_f32 v[16:17], v[16:17], v[18:19]
    v_pk_add_f32 v[16:17], v[16:17], v[20:21]
    v_pk_add_f32 v[16:17], v[16:17], v[22:23]
    v_pk_add_f32 v[16:17], v[16:17], v[24:25]
Lpoll_29:
    buffer_load_dwordx4 v[208:211], v12, s[64:67], s95 offen sc1
    buffer_load_dwordx4 v[212:215], v12, s[64:67], s95 offen offset:256 sc1
    s_add_u32 s76, s76, 1
    s_cmp_gt_u32 s76, 400000
    s_cbranch_scc1 L_end
    s_waitcnt vmcnt(0)
    v_cmp_ne_u64 vcc, s[72:73], v[210:211]
    v_cmp_ne_u64 s[98:99], s[72:73], v[214:215]
    s_or_b64 vcc, vcc, s[98:99]
    s_cbranch_vccnz Lpoll_29
    v_mov_b32 v210, v212
    v_mov_b32 v211, v213
    s_nop 1
    v_mfma_f32_16x16x32_bf16 v[184:187], v[208:211], v[48:51], 0
    v_mfma_f32_16x16x32_bf16 v[188:191], v[208:211], v[208:211], 0
    v_mfma_f32_16x16x32_bf16 v[144:147], v[208:211], v[80:83], 0
    v_mfma_f32_16x16x32_bf16 v[148:151], v[208:211], v[84:87], 0
    v_mfma_f32_16x16x32_bf16 v[152:155], v[208:211], v[88:91], 0
    v_mfma_f32_16x16x32_bf16 v[156:159], v[208:211], v[92:95], 0
    v_mfma_f32_16x16x32_bf16 v[160:163], v[208:211], v[96:99], 0
    v_mfma_f32_16x16x32_bf16 v[164:167], v[208:211], v[100:103], 0
    v_mfma_f32_16x16x32_bf16 v[168:171], v[208:211], v[104:107], 0
    v_mfma_f32_16x16x32_bf16 v[172:175], v[208:211], v[108:111], 0
    v_add_f32 v192, v184, v185
    v_add_f32_dpp v193, v189, v188 row_shl:1 row_mask:0xf bank_mask:0xf
    v_add_f32 v194, v186, v187
    s_nop 0
    v_add_f32_dpp v193, v190, v193 row_shl:2 row_mask:0xf bank_mask:0xf
    v_add_f32 v192, v192, v194
    s_nop 0
    v_add_f32_dpp v193, v191, v193 row_shl:3 row_mask:0xf bank_mask:0xf
    s_mov_b32 exec_lo, 0x100001
    s_mov_b32 exec_hi, 0x10000100
    ds_write_b64 v10, v[192:193]
    s_mov_b64 exec, -1
    v_add_f32_dpp v176, v145, v144 row_shl:4 row_mask:0xf bank_mask:0xf
    v_add_f32_dpp v177, v149, v148 row_shl:4 row_mask:0xf bank_mask:0xf
    v_add_f32_dpp v178, v153, v152 row_shl:4 row_mask:0xf bank_mask:0xf
    v_add_f32_dpp v179, v157, v156 row_shl:4 row_mask:0xf bank_mask:0xf
    v_add_f32_dpp v180, v161, v160 row_shl:4 row_mask:0xf bank_mask:0xf
    v_add_f32_dpp v181, v165, v164 row_shl:4 row_mask:0xf bank_mask:0xf
    v_add_f32_dpp v182, v169, v168 row_shl:4 row_mask:0xf bank_mask:0xf
    v_add_f32_dpp v183, v173, v172 row_shl:4 row_mask:0xf bank_mask:0xf
    v_add_f32_dpp v176, v146, v176 row_shl:8 row_mask:0xf bank_mask:0xf
    v_add_f32_dpp v177, v150, v177 row_shl:8 row_mask:0xf bank_mask:0xf
    v_add_f32_dpp v178, v154, v178 row_shl:8 row_mask:0xf bank_mask:0xf
    v_add_f32_dpp v179, v158, v179 row_shl:8 row_mask:0xf bank_mask:0xf
    v_add_f32_dpp v180, v162, v180 row_shl:8 row_mask:0xf bank_mask:0xf
    v_add_f32_dpp v181, v166, v181 row_shl:8 row_mask:0xf bank_mask:0xf
    v_add_f32_dpp v182, v170, v182 row_shl:8 row_mask:0xf bank_mask:0xf
    v_add_f32_dpp v183, v174, v183 row_shl:8 row_mask:0xf bank_mask:0xf
    v_add_f32_dpp v176, v147, v176 row_shl:12 row_mask:0xf bank_mask:0xf
    v_add_f32_dpp v177, v151, v177 row_shl:12 row_mask:0xf bank_mask:0xf
    v_add_f32_dpp v178, v155, v178 row_shl:12 row_mask:0xf bank_mask:0xf
    v_add_f32_dpp v179, v159, v179 row_shl:12 row_mask:0xf bank_mask:0xf
    v_add_f32_dpp v180, v163, v180 row_shl:12 row_mask:0xf bank_mask:0xf
    v_add_f32_dpp v181, v167, v181 row_shl:12 row_mask:0xf bank_mask:0xf
    v_add_f32_dpp v182, v171, v182 row_shl:12 row_mask:0xf bank_mask:0xf
    v_add_f32_dpp v183, v175, v183 row_shl:12 row_mask:0xf bank_mask:0xf
    s_mov_b32 exec_lo, 0xf000f
    s_mov_b32 exec_hi, 0xf000f
    ds_write_b128 v13, v[176:179]
    ds_write_b128 v13, v[180:183] offset:16
    s_mov_b64 exec, -1
    s_waitcnt lgkmcnt(0)
    s_barrier
    ds_read_b64 v[160:161], v11 offset:32768
    ds_read_b64 v[162:163], v11 offset:32800
    ds_read_b64 v[164:165], v11 offset:32832
    ds_read_b64 v[166:167], v11 offset:32864
    ds_read_b64 v[168:169], v11 offset:32896
    ds_read_b64 v[144:145], v14 offset:16384
    ds_read_b64 v[146:147], v14 offset:16896
    ds_read_b64 v[148:149], v14 offset:17408
    ds_read_b64 v[150:151], v14 offset:17920
    ds_read_b64 v[152:153], v14 offset:18432
    s_waitcnt lgkmcnt(5)
    v_pk_add_f32 v[160:161], v[160:161], v[162:163]
    v_pk_add_f32 v[160:161], v[160:161], v[164:165]
    v_pk_add_f32 v[160:161], v[160:161], v[166:167]
    v_pk_add_f32 v[160:161], v[160:161], v[168:169]
    v_mul_f32 v160, 0x3acccccd, v160
    v_mul_f32 v161, 0x3acccccd, v161
    v_fma_f32 v161, -v160, v160, v161
    v_max_f32 v161, 0, v161
    v_add_f32 v161, 0x3727c5ac, v161
    v_rsq_f32 v161, v161
    s_waitcnt lgkmcnt(0)
    v_pk_add_f32 v[144:145], v[144:145], v[146:147]
    v_pk_add_f32 v[144:145], v[144:145], v[148:149]
    v_pk_add_f32 v[144:145], v[144:145], v[150:151]
    v_pk_add_f32 v[144:145], v[144:145], v[152:153]
    v_fma_f32 v144, -v160, v16, v144
    v_fma_f32 v145, -v160, v17, v145
    v_mul_f32 v144, v144, v161
    v_mul_f32 v145, v145, v161
    v_mul_f32 v146, 0xbfb8aa3b, v144
    v_mul_f32 v147, 0xbfb8aa3b, v145
    v_exp_f32 v146, v146
    v_exp_f32 v147, v147
    s_nop 0
    v_add_f32 v146, 1.0, v146
    v_add_f32 v147, 1.0, v147
    v_rcp_f32 v146, v146
    v_rcp_f32 v147, v147
    s_nop 0
    v_mul_f32 v144, v144, v146
    v_mul_f32 v145, v145, v147
    v_cvt_pk_bf16_f32 v148, v144, v145
    s_nop 1
    v_mov_b32_dpp v208, v148 quad_perm:[0,0,0,0] row_mask:0xf bank_mask:0xf
    v_mov_b32_dpp v209, v148 quad_perm:[1,1,1,1] row_mask:0xf bank_mask:0xf
    v_mov_b32_dpp v210, v148 quad_perm:[2,2,2,2] row_mask:0xf bank_mask:0xf
    v_mov_b32_dpp v211, v148 quad_perm:[3,3,3,3] row_mask:0xf bank_mask:0xf
    s_nop 1
    v_mfma_f32_16x16x32_bf16 v[144:147], v[208:211], v[112:115], 0
    v_mfma_f32_16x16x32_bf16 v[148:151], v[208:211], v[116:119], 0
    v_mfma_f32_16x16x32_bf16 v[152:155], v[208:211], v[120:123], 0
    v_mfma_f32_16x16x32_bf16 v[156:159], v[208:211], v[124:127], 0
    v_mfma_f32_16x16x32_bf16 v[160:163], v[208:211], v[128:131], 0
    v_mfma_f32_16x16x32_bf16 v[164:167], v[208:211], v[132:135], 0
    v_mfma_f32_16x16x32_bf16 v[168:171], v[208:211], v[136:139], 0
    v_mfma_f32_16x16x32_bf16 v[172:175], v[208:211], v[140:143], 0
    s_nop 3
    v_cvt_pk_bf16_f32 v232, v144, v148
    v_cvt_pk_bf16_f32 v233, v152, v156
    buffer_store_dwordx4 v[232:235], v9, s[64:67], s96 offen sc1
    s_nop 1
    v_cvt_pk_bf16_f32 v236, v160, v164
    v_cvt_pk_bf16_f32 v237, v168, v172
    buffer_store_dwordx4 v[236:239], v9, s[64:67], s96 offen offset:256 sc1
L_fin:
L_end:
    s_endpgm
L_codeend:
.section .rodata,"a"
.p2align 6
.amdhsa_kernel sequential_preLN__compressed_kv_cla__dense_activation_silu__decode_kernel
  .amdhsa_next_free_vgpr 256
  .amdhsa_next_free_sgpr 102
  .amdhsa_accum_offset 256
  .amdhsa_group_segment_fixed_size 0
  .amdhsa_kernarg_size 96
  .amdhsa_user_sgpr_count 2
  .amdhsa_user_sgpr_kernarg_segment_ptr 1
  .amdhsa_system_sgpr_workgroup_id_x 1
.end_amdhsa_kernel
```
